```python
import torch

def _softmax(x, axis=-1):
    return torch.softmax(x, dim=axis)

def _gelu(x):
    return torch.nn.functional.gelu(x, approximate='tanh')

def _silu(x):
    return torch.nn.functional.silu(x)

def _sigmoid(x):
    return torch.sigmoid(x)

def _layernorm(x, axis=-1, eps=1e-05):
    m = x.mean(dim=axis, keepdim=True)
    v = x.var(dim=axis, keepdim=True, unbiased=False)
    return (x - m) / torch.sqrt(v + eps)

def _scatter_add(tgt, idx, src, axis=0):
    return tgt.clone().index_add_(axis, idx, src)

def _segment_sum(src, seg, n):
    out = torch.zeros((n,) + src.shape[1:], dtype=src.dtype)
    return out.index_add_(0, seg, src)

def _pad(x, pw):
    flat = tuple((v for pair in reversed(pw) for v in pair))
    return torch.nn.functional.pad(x, flat)
kernel_name = 'adaLN_cond__gqa_block_cached__geglu_ffn__decode'

def setup_inputs():

    _w = lambda a: (lambda t: t.to(torch.bfloat16) if t.is_floating_point() else t)(torch.as_tensor(a))

    def _A_setup():
        B, Sq, D = (4, 1, 512)
        Hq, Hkv, Sk, Dh = (32, 8, 8192, 128)
        assert Hq % Hkv == 0, (Hq, Hkv)
        return {'x': _w((lambda *s: torch.randn(*s, dtype=torch.bfloat16) * 0.1)(B, Sq, D)), 'k_cache': _w((lambda *s: torch.randn(*s, dtype=torch.bfloat16) * 0.8)(B, Hkv, Sk, Dh)), 'v_cache': _w((lambda *s: torch.randn(*s, dtype=torch.bfloat16) * 1.6)(B, Hkv, Sk, Dh)), 'wq': _w((lambda *s: torch.randn(*s, dtype=torch.bfloat16) * 0.8)(D, Hq * Dh) * D ** (-0.5)), 'wo': _w((lambda *s: torch.randn(*s, dtype=torch.bfloat16) * 1.6)(Hq * Dh, D) * (Hq * Dh) ** (-0.5))}
    _A_in = _A_setup()

    def _B_setup():
        B, S, D, F = (4, 1, 512, 1792)
        return {'x': _w((lambda *s: torch.randn(*s, dtype=torch.bfloat16) * 0.1)(B, S, D)), 'w_gate': _w((lambda *s: torch.randn(*s, dtype=torch.bfloat16) * 0.1)(D, F)), 'w_up': _w((lambda *s: torch.randn(*s, dtype=torch.bfloat16) * 0.1)(D, F)), 'w_down': _w((lambda *s: torch.randn(*s, dtype=torch.bfloat16) * 0.1)(F, D))}
    _B_in = _B_setup()
    return {'A_x': _A_in['x'], 'A_k_cache': _A_in['k_cache'], 'A_v_cache': _A_in['v_cache'], 'A_wq': _A_in['wq'], 'A_wo': _A_in['wo'], 'B_x': _B_in['x'], 'B_w_gate': _B_in['w_gate'], 'B_w_up': _B_in['w_up'], 'B_w_down': _B_in['w_down'], 'c': _w((lambda *s: torch.randn(*s, dtype=torch.bfloat16) * 0.8)(4, 512) * 8.0), 'w_mod': _w((lambda *s: torch.randn(*s, dtype=torch.bfloat16) * 0.8)(512, 6 * 512) * 512 ** (-0.5) * 8.0)}

def reference(A_x, A_k_cache, A_v_cache, A_wq, A_wo, B_x, B_w_gate, B_w_up, B_w_down, c, w_mod):

    def _A_ref(x, k_cache, v_cache, wq, wo):
        B, Sq, D = x.shape
        Hq, Dh = (32, 128)
        Hkv = k_cache.shape[1]
        rep = Hq // Hkv
        q = (lambda x, *d: x.permute(*d))((x @ wq).reshape(B, Sq, Hq, Dh), 0, 2, 1, 3)
        k = (lambda x, n, axis: torch.repeat_interleave(x, n, dim=axis))(k_cache, rep, axis=1)
        v = (lambda x, n, axis: torch.repeat_interleave(x, n, dim=axis))(v_cache, rep, axis=1)
        scores = torch.einsum('bhqd,bhkd->bhqk', q, k) * Dh ** (-0.5)
        p = _softmax(scores, axis=-1)
        o = torch.einsum('bhqk,bhkd->bhqd', p, v)
        return (lambda x, *d: x.permute(*d))(o, 0, 2, 1, 3).reshape(B, Sq, Hq * Dh) @ wo

    def _B_ref(x, w_gate, w_up, w_down):
        return _gelu(x @ w_gate) * (x @ w_up) @ w_down
    x = A_x
    mod = (_silu(c) @ w_mod).reshape(c.shape[0], 6, 1, -1)
    sa, ca, ga, sb, cb, gb = (mod[:, 0].clone(), mod[:, 1].clone(), mod[:, 2].clone(), mod[:, 3].clone(), mod[:, 4].clone(), mod[:, 5].clone())
    h = _layernorm(x, axis=-1) * (1 + ca) + sa
    x = x + ga * _A_ref(h, A_k_cache, A_v_cache, A_wq, A_wo)
    h = _layernorm(x, axis=-1) * (1 + cb) + sb
    x = x + gb * _B_ref(h, B_w_gate, B_w_up, B_w_down)
    return x
```

```asm
; @launch grid=(256,1,1) block=(768,1,1) lds=158592
.amdgcn_target "amdgcn-amd-amdhsa--gfx950"
.text
.globl adaLN_cond__gqa_block_cached__geglu_ffn__decode_kernel
.p2align 8
.type adaLN_cond__gqa_block_cached__geglu_ffn__decode_kernel,@function
adaLN_cond__gqa_block_cached__geglu_ffn__decode_kernel:
    s_cmp_ge_u32 s2, 256
    s_cbranch_scc1 L_end
    s_load_dwordx16 s[4:19], s[0:1], 0
    s_load_dwordx8 s[20:27], s[0:1], 64
    s_load_dwordx4 s[28:31], s[0:1], 96
    v_lshrrev_b32 v1, 6, v0
    v_and_b32 v0, 63, v0
    v_readfirstlane_b32 s3, v1
    v_and_b32 v1, 15, v0
    v_lshrrev_b32 v2, 4, v0
    s_and_b32 s60, s2, 7
    s_lshr_b32 s61, s2, 3
    s_lshr_b32 s65, s61, 3
    s_mov_b32 s66, s60
    s_lshl_b32 s62, s65, 3
    s_add_u32 s62, s62, s66
    s_lshl_b32 s62, s62, 3
    s_and_b32 s74, s61, 7
    s_add_u32 s62, s62, s74
    s_cmp_lt_u32 s3, 8
    s_cbranch_scc1 L_kwave
    s_setprio 3
    s_sub_u32 s69, s3, 8
    v_mov_b32 v4, 0
    v_lshlrev_b32 v5, 2, v1
    v_add_u32 v5, 140544, v5
    ds_write_b32 v5, v4
    s_lshr_b32 s74, s61, 3
    s_lshl_b32 s74, s74, 1
    s_and_b32 s75, s61, 1
    s_add_u32 s59, s74, s75
    s_lshr_b32 s61, s61, 1
    s_and_b32 s61, s61, 3
    s_lshl_b32 s64, s60, 3
    s_add_u32 s64, s64, s59
    s_lshr_b32 s72, s60, 1
    s_cmp_lg_u32 s61, 0
    s_cbranch_scc1 L_role1h
    s_bitcmp1_b32 s60, 0
    s_cselect_b32 s73, 18, 14
    s_cselect_b32 s75, 6, 6
    s_lshl_b32 s64, s72, 3
    s_add_u32 s64, s64, s73
    s_add_u32 s64, s64, s59
    s_lshl_b32 s74, s60, 1
    s_add_u32 s74, s74, s59
    s_cmp_lt_u32 s59, 2
    s_cselect_b32 s64, s74, s64
    s_cselect_b32 s61, 0, 4
    s_cmp_ge_u32 s59, s75
    s_cselect_b32 s61, 5, s61
L_role1h:
    s_cmp_lg_u32 s61, 3
    s_cbranch_scc1 L_role2h
    s_bitcmp1_b32 s60, 0
    s_cselect_b32 s73, 7, 0
    s_cselect_b32 s75, 7, 7
    s_mul_i32 s64, s72, 14
    s_add_u32 s64, s64, s73
    s_add_u32 s64, s64, s59
    s_cmp_ge_u32 s59, s75
    s_cselect_b32 s61, 5, 3
L_role2h:
    s_cmp_lg_u32 s61, 2
    s_cbranch_scc1 L_role3h
    s_mov_b32 s64, s59
L_role3h:
    s_mov_b32 s70, 0x05040100
    s_mov_b32 s71, 0x07060302
    s_cmp_eq_u32 s61, 1
    s_cbranch_scc1 L_h_q
    s_cmp_eq_u32 s61, 0
    s_cbranch_scc1 L_h_modc
    s_branch L_h_other
L_kwave:
    s_lshl_b32 s67, s62, 18
    s_lshl_b32 s68, s3, 10
    v_lshrrev_b32 v3, 2, v1
    v_lshlrev_b32 v3, 8, v3
    v_lshl_add_u32 v3, v2, 6, v3
    v_and_b32 v4, 3, v0
    v_lshl_add_u32 v3, v4, 4, v3
    v_add_u32 v3, s68, v3
    s_waitcnt lgkmcnt(0)
    s_add_u32 s32, s6, s67
    s_addc_u32 s33, s7, 0
    s_mov_b32 s34, 262144
    s_mov_b32 s35, 0x20000
    s_mul_i32 s55, s65, 8192
    s_add_u32 s74, s55, 0
    s_and_b32 s74, s74, 0x3ffff
    buffer_load_dwordx4 v[40:43], v3, s[32:35], s74 offen nt
    s_add_u32 s74, s55, 8192
    s_and_b32 s74, s74, 0x3ffff
    buffer_load_dwordx4 v[44:47], v3, s[32:35], s74 offen nt
    s_add_u32 s74, s55, 16384
    s_and_b32 s74, s74, 0x3ffff
    buffer_load_dwordx4 v[48:51], v3, s[32:35], s74 offen nt
    s_waitcnt lgkmcnt(0)
    s_load_dword s63, s[30:31], 0
    s_mov_b32 s40, s30
    s_mov_b32 s41, s31
    s_mov_b32 s42, 2097152
    s_mov_b32 s43, 0x20000
    s_add_u32 s36, s8, s67
    s_addc_u32 s37, s9, 0
    s_mov_b32 s38, 262144
    s_mov_b32 s39, 0x20000
    s_lshr_b32 s74, s61, 3
    s_lshl_b32 s74, s74, 1
    s_and_b32 s75, s61, 1
    s_add_u32 s59, s74, s75
    s_lshr_b32 s61, s61, 1
    s_and_b32 s61, s61, 3
    s_lshl_b32 s64, s60, 3
    s_add_u32 s64, s64, s59
    s_lshr_b32 s72, s60, 1
    s_cmp_lg_u32 s61, 0
    s_cbranch_scc1 L_role1k
    s_bitcmp1_b32 s60, 0
    s_cselect_b32 s73, 18, 14
    s_cselect_b32 s75, 6, 6
    s_lshl_b32 s64, s72, 3
    s_add_u32 s64, s64, s73
    s_add_u32 s64, s64, s59
    s_lshl_b32 s74, s60, 1
    s_add_u32 s74, s74, s59
    s_cmp_lt_u32 s59, 2
    s_cselect_b32 s64, s74, s64
    s_cselect_b32 s61, 0, 4
    s_cmp_ge_u32 s59, s75
    s_cselect_b32 s61, 5, s61
L_role1k:
    s_cmp_lg_u32 s61, 3
    s_cbranch_scc1 L_role2k
    s_bitcmp1_b32 s60, 0
    s_cselect_b32 s73, 7, 0
    s_cselect_b32 s75, 7, 7
    s_mul_i32 s64, s72, 14
    s_add_u32 s64, s64, s73
    s_add_u32 s64, s64, s59
    s_cmp_ge_u32 s59, s75
    s_cselect_b32 s61, 5, 3
L_role2k:
    s_cmp_lg_u32 s61, 2
    s_cbranch_scc1 L_role3k
    s_mov_b32 s64, s59
L_role3k:
    s_mov_b32 s70, 0x05040100
    s_mov_b32 s71, 0x07060302
    v_lshl_add_u32 v4, v0, 4, s68
    s_lshl_b32 s75, s3, 14
    s_mov_b32 s74, 0x1010
    s_lshl_b32 s73, s61, 2
    s_lshr_b32 s57, s74, s73
    s_and_b32 s57, s57, 0xf
    s_mov_b32 s74, 23
    s_lshr_b32 s74, s74, s61
    s_and_b32 s74, s74, 1
    s_and_b32 s73, s64, 7
    s_cmp_eq_u32 s73, 3
    s_cselect_b32 s74, s74, 0
    s_or_b32 s57, s57, s74
    s_cmp_lg_u32 s57, 0
    s_cselect_b64 s[78:79], -1, 0
    s_cmp_lt_u32 s3, 4
    s_cbranch_scc1 L_noy
    s_setprio 1
L_noy:
    s_mov_b64 vcc, s[78:79]
    s_barrier
    s_add_u32 s74, s55, 24576
    s_and_b32 s74, s74, 0x3ffff
    s_cbranch_vccnz L_pc_1
    s_waitcnt vmcnt(2)
L_pc_1:
    s_waitcnt vmcnt(3)
    buffer_load_dwordx4 v[52:55], v3, s[32:35], s74 offen nt
    s_add_u32 s74, s55, 32768
    s_and_b32 s74, s74, 0x3ffff
    s_cbranch_vccnz L_pc_2
    s_waitcnt vmcnt(2)
L_pc_2:
    s_waitcnt vmcnt(3)
    buffer_load_dwordx4 v[56:59], v3, s[32:35], s74 offen nt
    s_add_u32 s74, s55, 40960
    s_and_b32 s74, s74, 0x3ffff
    s_cbranch_vccnz L_pc_3
    s_waitcnt vmcnt(2)
L_pc_3:
    s_waitcnt vmcnt(3)
    buffer_load_dwordx4 v[60:63], v3, s[32:35], s74 offen nt
    s_add_u32 s74, s55, 49152
    s_and_b32 s74, s74, 0x3ffff
    s_cbranch_vccnz L_pc_4
    s_waitcnt vmcnt(2)
L_pc_4:
    s_waitcnt vmcnt(3)
    buffer_load_dwordx4 v[64:67], v3, s[32:35], s74 offen nt
    s_add_u32 s74, s55, 57344
    s_and_b32 s74, s74, 0x3ffff
    s_cbranch_vccnz L_pc_5
    s_waitcnt vmcnt(2)
L_pc_5:
    s_waitcnt vmcnt(3)
    buffer_load_dwordx4 v[68:71], v3, s[32:35], s74 offen nt
    s_add_u32 s74, s55, 65536
    s_and_b32 s74, s74, 0x3ffff
    s_cbranch_vccnz L_pc_6
    s_waitcnt vmcnt(2)
L_pc_6:
    s_waitcnt vmcnt(3)
    buffer_load_dwordx4 v[72:75], v3, s[32:35], s74 offen nt
    s_add_u32 s74, s55, 73728
    s_and_b32 s74, s74, 0x3ffff
    s_cbranch_vccnz L_pc_7
    s_waitcnt vmcnt(2)
L_pc_7:
    s_waitcnt vmcnt(3)
    buffer_load_dwordx4 v[76:79], v3, s[32:35], s74 offen nt
    s_add_u32 s74, s55, 81920
    s_and_b32 s74, s74, 0x3ffff
    s_cbranch_vccnz L_pc_8
    s_waitcnt vmcnt(2)
L_pc_8:
    s_waitcnt vmcnt(3)
    buffer_load_dwordx4 v[80:83], v3, s[32:35], s74 offen nt
    s_add_u32 s74, s55, 90112
    s_and_b32 s74, s74, 0x3ffff
    s_cbranch_vccnz L_pc_9
    s_waitcnt vmcnt(2)
L_pc_9:
    s_waitcnt vmcnt(3)
    buffer_load_dwordx4 v[84:87], v3, s[32:35], s74 offen nt
    s_add_u32 s74, s55, 98304
    s_and_b32 s74, s74, 0x3ffff
    s_cbranch_vccnz L_pc_10
    s_waitcnt vmcnt(2)
L_pc_10:
    s_waitcnt vmcnt(3)
    buffer_load_dwordx4 v[88:91], v3, s[32:35], s74 offen nt
    v_mov_b32 v5, 140600
    v_mov_b32 v6, 1
    s_mov_b64 exec, 1
    ds_write_b32 v5, v6
    s_mov_b64 exec, -1
    s_add_u32 s74, s55, 106496
    s_and_b32 s74, s74, 0x3ffff
    s_cbranch_vccnz L_pc_11
    s_waitcnt vmcnt(2)
L_pc_11:
    s_waitcnt vmcnt(3)
    buffer_load_dwordx4 v[92:95], v3, s[32:35], s74 offen nt
    s_add_u32 s74, s55, 114688
    s_and_b32 s74, s74, 0x3ffff
    s_cbranch_vccnz L_pc_12
    s_waitcnt vmcnt(2)
L_pc_12:
    s_waitcnt vmcnt(3)
    buffer_load_dwordx4 v[96:99], v3, s[32:35], s74 offen nt
    s_add_u32 s74, s55, 122880
    s_and_b32 s74, s74, 0x3ffff
    s_cbranch_vccnz L_pc_13
    s_waitcnt vmcnt(2)
L_pc_13:
    s_waitcnt vmcnt(3)
    buffer_load_dwordx4 v[100:103], v3, s[32:35], s74 offen nt
    s_add_u32 s74, s55, 131072
    s_and_b32 s74, s74, 0x3ffff
    s_cbranch_vccnz L_pc_14
    s_waitcnt vmcnt(2)
L_pc_14:
    s_waitcnt vmcnt(3)
    buffer_load_dwordx4 v[104:107], v3, s[32:35], s74 offen nt
    s_add_u32 s74, s55, 139264
    s_and_b32 s74, s74, 0x3ffff
    s_cbranch_vccnz L_pc_15
    s_waitcnt vmcnt(2)
L_pc_15:
    s_waitcnt vmcnt(3)
    buffer_load_dwordx4 v[108:111], v3, s[32:35], s74 offen nt
    s_add_u32 s74, s55, 147456
    s_and_b32 s74, s74, 0x3ffff
    s_cbranch_vccnz L_pc_16
    s_waitcnt vmcnt(2)
L_pc_16:
    s_waitcnt vmcnt(3)
    buffer_load_dwordx4 v[112:115], v3, s[32:35], s74 offen nt
    s_add_u32 s74, s55, 155648
    s_and_b32 s74, s74, 0x3ffff
    s_cbranch_vccnz L_pc_17
    s_waitcnt vmcnt(2)
L_pc_17:
    s_waitcnt vmcnt(3)
    buffer_load_dwordx4 v[116:119], v3, s[32:35], s74 offen nt
    s_add_u32 s74, s55, 163840
    s_and_b32 s74, s74, 0x3ffff
    s_cbranch_vccnz L_pc_18
    s_waitcnt vmcnt(2)
L_pc_18:
    s_waitcnt vmcnt(3)
    buffer_load_dwordx4 v[120:123], v3, s[32:35], s74 offen nt
    s_add_u32 s74, s55, 172032
    s_and_b32 s74, s74, 0x3ffff
    s_cbranch_vccnz L_pc_19
    s_waitcnt vmcnt(2)
L_pc_19:
    s_waitcnt vmcnt(3)
    buffer_load_dwordx4 v[124:127], v3, s[32:35], s74 offen nt
    s_add_u32 s74, s55, 180224
    s_and_b32 s74, s74, 0x3ffff
    s_cbranch_vccnz L_pc_20
    s_waitcnt vmcnt(2)
L_pc_20:
    s_waitcnt vmcnt(3)
    buffer_load_dwordx4 v[128:131], v3, s[32:35], s74 offen nt
    s_add_u32 s74, s55, 188416
    s_and_b32 s74, s74, 0x3ffff
    s_cbranch_vccnz L_pc_21
    s_waitcnt vmcnt(2)
L_pc_21:
    s_waitcnt vmcnt(3)
    buffer_load_dwordx4 v[132:135], v3, s[32:35], s74 offen nt
    s_add_u32 s74, s55, 196608
    s_and_b32 s74, s74, 0x3ffff
    s_cbranch_vccnz L_pc_22
    s_waitcnt vmcnt(2)
L_pc_22:
    s_waitcnt vmcnt(3)
    buffer_load_dwordx4 v[136:139], v3, s[32:35], s74 offen nt
    s_add_u32 s74, s55, 204800
    s_and_b32 s74, s74, 0x3ffff
    s_cbranch_vccnz L_pc_23
    s_waitcnt vmcnt(2)
L_pc_23:
    s_waitcnt vmcnt(3)
    buffer_load_dwordx4 v[140:143], v3, s[32:35], s74 offen nt
    s_add_u32 s74, s55, 212992
    s_and_b32 s74, s74, 0x3ffff
    s_cbranch_vccnz L_pc_24
    s_waitcnt vmcnt(2)
L_pc_24:
    s_waitcnt vmcnt(3)
    buffer_load_dwordx4 v[144:147], v3, s[32:35], s74 offen nt
    s_add_u32 s74, s55, 221184
    s_and_b32 s74, s74, 0x3ffff
    s_cbranch_vccnz L_pc_25
    s_waitcnt vmcnt(2)
L_pc_25:
    s_waitcnt vmcnt(3)
    buffer_load_dwordx4 v[148:151], v3, s[32:35], s74 offen nt
    s_add_u32 s74, s55, 229376
    s_and_b32 s74, s74, 0x3ffff
    s_cbranch_vccnz L_pc_26
    s_waitcnt vmcnt(2)
L_pc_26:
    s_waitcnt vmcnt(3)
    buffer_load_dwordx4 v[152:155], v3, s[32:35], s74 offen nt
    s_add_u32 s74, s55, 237568
    s_and_b32 s74, s74, 0x3ffff
    s_cbranch_vccnz L_pc_27
    s_waitcnt vmcnt(2)
L_pc_27:
    s_waitcnt vmcnt(3)
    buffer_load_dwordx4 v[156:159], v3, s[32:35], s74 offen nt
    s_add_u32 s74, s55, 245760
    s_and_b32 s74, s74, 0x3ffff
    s_cbranch_vccnz L_pc_28
    s_waitcnt vmcnt(2)
L_pc_28:
    s_waitcnt vmcnt(3)
    buffer_load_dwordx4 v[160:163], v3, s[32:35], s74 offen nt
    s_add_u32 s74, s55, 253952
    s_and_b32 s74, s74, 0x3ffff
    s_cbranch_vccnz L_pc_29
    s_waitcnt vmcnt(2)
L_pc_29:
    s_waitcnt vmcnt(3)
    buffer_load_dwordx4 v[164:167], v3, s[32:35], s74 offen nt
    s_mov_b32 s56, 0
    s_mov_b32 s58, s75
    v_mov_b32 v6, 140560
L_v1a:
    s_mov_b32 m0, s58
    s_add_u32 s74, s55, s56
    s_and_b32 s74, s74, 0x3ffff
    s_cbranch_vccnz L_pc_30
    s_waitcnt vmcnt(2)
L_pc_30:
    s_waitcnt vmcnt(3)
    buffer_load_dwordx4 v4, s[36:39], s74 offen nt lds
    s_add_u32 s58, s58, 1024
    s_add_u32 s56, s56, 8192
    s_cmp_lg_u32 s56, 32768
    s_cbranch_scc1 L_nokp
    v_mov_b32 v5, 140564
    v_mov_b32 v7, 1
    s_mov_b64 exec, 1
    ds_write_b32 v5, v7
    s_mov_b64 exec, -1
L_nokp:
    s_cmp_lt_u32 s56, 49152
    s_cbranch_scc1 L_v1a
    s_cmp_ge_u32 s56, 131072
    s_cbranch_scc1 L_qkblk
    ds_read_b32 v7, v6
    s_waitcnt lgkmcnt(0)
    v_readfirstlane_b32 s74, v7
    s_nop 0
    s_cmp_eq_u32 s74, 0
    s_cbranch_scc1 L_v1a
    s_branch L_qk
L_qkblk:
L_qk:
    v_and_b32 v5, 3, v0
    v_lshlrev_b32 v5, 8, v5
    v_lshrrev_b32 v6, 2, v1
    v_lshl_add_u32 v5, v6, 4, v5
    v_lshl_add_u32 v5, v2, 6, v5
    v_add_u32 v5, 131072, v5
    v_mov_b32 v6, 140560
    s_mov_b32 s72, 64000000
L_lw_31:
    ds_read_b32 v16, v6
    s_waitcnt lgkmcnt(0)
    v_cmp_ne_u32 vcc, 1, v16
    s_nop 0
    s_cbranch_vccz L_lwdone_32
    s_sleep 1
    s_sub_u32 s72, s72, 1
    s_cmp_lg_u32 s72, 0
    s_cbranch_scc1 L_lw_31
L_lwdone_32:
    s_add_u32 s63, s63, 2654435769
    ds_read_b128 v[16:19], v5
    s_mov_b64 vcc, s[78:79]
    s_waitcnt lgkmcnt(0)
    v_mfma_f32_16x16x32_bf16 v[20:23], v[40:43], v[16:19], 0
    v_mfma_f32_16x16x32_bf16 v[24:27], v[44:47], v[16:19], 0
    s_add_u32 s74, s55, 131072
    s_and_b32 s74, s74, 0x3ffff
    s_cbranch_vccnz L_pc_33
    s_waitcnt vmcnt(4)
L_pc_33:
    s_waitcnt vmcnt(5)
    buffer_load_dwordx4 v[40:43], v4, s[36:39], s74 offen nt
    v_mfma_f32_16x16x32_bf16 v[28:31], v[48:51], v[16:19], 0
    s_add_u32 s74, s55, 139264
    s_and_b32 s74, s74, 0x3ffff
    s_cbranch_vccnz L_pc_34
    s_waitcnt vmcnt(4)
L_pc_34:
    s_waitcnt vmcnt(5)
    buffer_load_dwordx4 v[44:47], v4, s[36:39], s74 offen nt
    v_add_f32_dpp v37, v23, v22 row_ror:12 row_mask:0xf bank_mask:0xf
    v_add_f32_dpp v36, v21, v20 row_ror:12 row_mask:0xf bank_mask:0xf
    v_mfma_f32_16x16x32_bf16 v[32:35], v[52:55], v[16:19], 0
    v_add_f32_dpp v39, v24, v27 row_ror:12 row_mask:0xf bank_mask:0xf
    v_add_f32_dpp v38, v26, v25 row_ror:12 row_mask:0xf bank_mask:0xf
    v_add_f32_dpp v8, v37, v36 row_ror:8 row_mask:0xf bank_mask:0x1
    v_mfma_f32_16x16x32_bf16 v[20:23], v[56:59], v[16:19], 0
    v_add_f32_dpp v37, v29, v28 row_ror:12 row_mask:0xf bank_mask:0xf
    v_add_f32_dpp v36, v31, v30 row_ror:12 row_mask:0xf bank_mask:0xf
    v_add_f32_dpp v8, v39, v38 row_ror:8 row_mask:0xf bank_mask:0x2
    v_mfma_f32_16x16x32_bf16 v[24:27], v[60:63], v[16:19], 0
    v_add_f32_dpp v39, v34, v33 row_ror:12 row_mask:0xf bank_mask:0xf
    v_add_f32_dpp v38, v32, v35 row_ror:12 row_mask:0xf bank_mask:0xf
    v_add_f32_dpp v8, v37, v36 row_ror:8 row_mask:0xf bank_mask:0x4
    v_mfma_f32_16x16x32_bf16 v[28:31], v[64:67], v[16:19], 0
    v_add_f32_dpp v37, v23, v22 row_ror:12 row_mask:0xf bank_mask:0xf
    v_add_f32_dpp v36, v21, v20 row_ror:12 row_mask:0xf bank_mask:0xf
    v_add_f32_dpp v8, v39, v38 row_ror:8 row_mask:0xf bank_mask:0x8
    v_mfma_f32_16x16x32_bf16 v[32:35], v[68:71], v[16:19], 0
    v_add_f32_dpp v39, v24, v27 row_ror:12 row_mask:0xf bank_mask:0xf
    v_add_f32_dpp v38, v26, v25 row_ror:12 row_mask:0xf bank_mask:0xf
    v_add_f32_dpp v9, v37, v36 row_ror:8 row_mask:0xf bank_mask:0x1
    v_mfma_f32_16x16x32_bf16 v[20:23], v[72:75], v[16:19], 0
    v_add_f32_dpp v37, v29, v28 row_ror:12 row_mask:0xf bank_mask:0xf
    v_add_f32_dpp v36, v31, v30 row_ror:12 row_mask:0xf bank_mask:0xf
    v_add_f32_dpp v9, v39, v38 row_ror:8 row_mask:0xf bank_mask:0x2
    v_mfma_f32_16x16x32_bf16 v[24:27], v[76:79], v[16:19], 0
    v_add_f32_dpp v39, v34, v33 row_ror:12 row_mask:0xf bank_mask:0xf
    v_add_f32_dpp v38, v32, v35 row_ror:12 row_mask:0xf bank_mask:0xf
    v_add_f32_dpp v9, v37, v36 row_ror:8 row_mask:0xf bank_mask:0x4
    v_mfma_f32_16x16x32_bf16 v[28:31], v[80:83], v[16:19], 0
    v_add_f32_dpp v37, v23, v22 row_ror:12 row_mask:0xf bank_mask:0xf
    v_add_f32_dpp v36, v21, v20 row_ror:12 row_mask:0xf bank_mask:0xf
    v_add_f32_dpp v9, v39, v38 row_ror:8 row_mask:0xf bank_mask:0x8
    v_mfma_f32_16x16x32_bf16 v[32:35], v[84:87], v[16:19], 0
    v_add_f32_dpp v39, v24, v27 row_ror:12 row_mask:0xf bank_mask:0xf
    v_add_f32_dpp v38, v26, v25 row_ror:12 row_mask:0xf bank_mask:0xf
    v_add_f32_dpp v10, v37, v36 row_ror:8 row_mask:0xf bank_mask:0x1
    v_mfma_f32_16x16x32_bf16 v[20:23], v[88:91], v[16:19], 0
    v_add_f32_dpp v37, v29, v28 row_ror:12 row_mask:0xf bank_mask:0xf
    v_add_f32_dpp v36, v31, v30 row_ror:12 row_mask:0xf bank_mask:0xf
    v_add_f32_dpp v10, v39, v38 row_ror:8 row_mask:0xf bank_mask:0x2
    v_mfma_f32_16x16x32_bf16 v[24:27], v[92:95], v[16:19], 0
    v_add_f32_dpp v39, v34, v33 row_ror:12 row_mask:0xf bank_mask:0xf
    v_add_f32_dpp v38, v32, v35 row_ror:12 row_mask:0xf bank_mask:0xf
    v_add_f32_dpp v10, v37, v36 row_ror:8 row_mask:0xf bank_mask:0x4
    v_mfma_f32_16x16x32_bf16 v[28:31], v[96:99], v[16:19], 0
    v_add_f32_dpp v37, v23, v22 row_ror:12 row_mask:0xf bank_mask:0xf
    v_add_f32_dpp v36, v21, v20 row_ror:12 row_mask:0xf bank_mask:0xf
    v_add_f32_dpp v10, v39, v38 row_ror:8 row_mask:0xf bank_mask:0x8
    v_mfma_f32_16x16x32_bf16 v[32:35], v[100:103], v[16:19], 0
    v_add_f32_dpp v39, v24, v27 row_ror:12 row_mask:0xf bank_mask:0xf
    v_add_f32_dpp v38, v26, v25 row_ror:12 row_mask:0xf bank_mask:0xf
    v_add_f32_dpp v11, v37, v36 row_ror:8 row_mask:0xf bank_mask:0x1
    v_mfma_f32_16x16x32_bf16 v[20:23], v[104:107], v[16:19], 0
    v_add_f32_dpp v37, v29, v28 row_ror:12 row_mask:0xf bank_mask:0xf
    v_add_f32_dpp v36, v31, v30 row_ror:12 row_mask:0xf bank_mask:0xf
    v_add_f32_dpp v11, v39, v38 row_ror:8 row_mask:0xf bank_mask:0x2
    v_mfma_f32_16x16x32_bf16 v[24:27], v[108:111], v[16:19], 0
    v_add_f32_dpp v39, v34, v33 row_ror:12 row_mask:0xf bank_mask:0xf
    v_add_f32_dpp v38, v32, v35 row_ror:12 row_mask:0xf bank_mask:0xf
    v_add_f32_dpp v11, v37, v36 row_ror:8 row_mask:0xf bank_mask:0x4
    v_mfma_f32_16x16x32_bf16 v[28:31], v[112:115], v[16:19], 0
    v_add_f32_dpp v37, v23, v22 row_ror:12 row_mask:0xf bank_mask:0xf
    v_add_f32_dpp v36, v21, v20 row_ror:12 row_mask:0xf bank_mask:0xf
    v_add_f32_dpp v11, v39, v38 row_ror:8 row_mask:0xf bank_mask:0x8
    v_mfma_f32_16x16x32_bf16 v[32:35], v[116:119], v[16:19], 0
    v_add_f32_dpp v39, v24, v27 row_ror:12 row_mask:0xf bank_mask:0xf
    v_add_f32_dpp v38, v26, v25 row_ror:12 row_mask:0xf bank_mask:0xf
    v_add_f32_dpp v12, v37, v36 row_ror:8 row_mask:0xf bank_mask:0x1
    v_mfma_f32_16x16x32_bf16 v[20:23], v[120:123], v[16:19], 0
    s_add_u32 s74, s55, 147456
    s_and_b32 s74, s74, 0x3ffff
    s_cbranch_vccnz L_pc_35
    s_waitcnt vmcnt(4)
L_pc_35:
    s_waitcnt vmcnt(5)
    buffer_load_dwordx4 v[48:51], v4, s[36:39], s74 offen nt
    v_add_f32_dpp v37, v29, v28 row_ror:12 row_mask:0xf bank_mask:0xf
    v_add_f32_dpp v36, v31, v30 row_ror:12 row_mask:0xf bank_mask:0xf
    v_add_f32_dpp v12, v39, v38 row_ror:8 row_mask:0xf bank_mask:0x2
    v_mfma_f32_16x16x32_bf16 v[24:27], v[124:127], v[16:19], 0
    v_add_f32_dpp v39, v34, v33 row_ror:12 row_mask:0xf bank_mask:0xf
    v_add_f32_dpp v38, v32, v35 row_ror:12 row_mask:0xf bank_mask:0xf
    v_add_f32_dpp v12, v37, v36 row_ror:8 row_mask:0xf bank_mask:0x4
    v_mfma_f32_16x16x32_bf16 v[28:31], v[128:131], v[16:19], 0
    v_add_f32_dpp v37, v23, v22 row_ror:12 row_mask:0xf bank_mask:0xf
    v_add_f32_dpp v36, v21, v20 row_ror:12 row_mask:0xf bank_mask:0xf
    v_add_f32_dpp v12, v39, v38 row_ror:8 row_mask:0xf bank_mask:0x8
    v_mfma_f32_16x16x32_bf16 v[32:35], v[132:135], v[16:19], 0
    v_add_f32_dpp v39, v24, v27 row_ror:12 row_mask:0xf bank_mask:0xf
    v_add_f32_dpp v38, v26, v25 row_ror:12 row_mask:0xf bank_mask:0xf
    v_add_f32_dpp v13, v37, v36 row_ror:8 row_mask:0xf bank_mask:0x1
    v_mfma_f32_16x16x32_bf16 v[20:23], v[136:139], v[16:19], 0
    v_add_f32_dpp v37, v29, v28 row_ror:12 row_mask:0xf bank_mask:0xf
    v_add_f32_dpp v36, v31, v30 row_ror:12 row_mask:0xf bank_mask:0xf
    v_add_f32_dpp v13, v39, v38 row_ror:8 row_mask:0xf bank_mask:0x2
    v_mfma_f32_16x16x32_bf16 v[24:27], v[140:143], v[16:19], 0
    v_add_f32_dpp v39, v34, v33 row_ror:12 row_mask:0xf bank_mask:0xf
    v_add_f32_dpp v38, v32, v35 row_ror:12 row_mask:0xf bank_mask:0xf
    v_add_f32_dpp v13, v37, v36 row_ror:8 row_mask:0xf bank_mask:0x4
    v_mfma_f32_16x16x32_bf16 v[28:31], v[144:147], v[16:19], 0
    v_add_f32_dpp v37, v23, v22 row_ror:12 row_mask:0xf bank_mask:0xf
    v_add_f32_dpp v36, v21, v20 row_ror:12 row_mask:0xf bank_mask:0xf
    v_add_f32_dpp v13, v39, v38 row_ror:8 row_mask:0xf bank_mask:0x8
    v_mfma_f32_16x16x32_bf16 v[32:35], v[148:151], v[16:19], 0
    v_add_f32_dpp v39, v24, v27 row_ror:12 row_mask:0xf bank_mask:0xf
    v_add_f32_dpp v38, v26, v25 row_ror:12 row_mask:0xf bank_mask:0xf
    v_add_f32_dpp v14, v37, v36 row_ror:8 row_mask:0xf bank_mask:0x1
    v_mfma_f32_16x16x32_bf16 v[20:23], v[152:155], v[16:19], 0
    v_add_f32_dpp v37, v29, v28 row_ror:12 row_mask:0xf bank_mask:0xf
    v_add_f32_dpp v36, v31, v30 row_ror:12 row_mask:0xf bank_mask:0xf
    v_add_f32_dpp v14, v39, v38 row_ror:8 row_mask:0xf bank_mask:0x2
    v_mfma_f32_16x16x32_bf16 v[24:27], v[156:159], v[16:19], 0
    v_add_f32_dpp v39, v34, v33 row_ror:12 row_mask:0xf bank_mask:0xf
    v_add_f32_dpp v38, v32, v35 row_ror:12 row_mask:0xf bank_mask:0xf
    v_add_f32_dpp v14, v37, v36 row_ror:8 row_mask:0xf bank_mask:0x4
    v_mfma_f32_16x16x32_bf16 v[28:31], v[160:163], v[16:19], 0
    v_add_f32_dpp v37, v23, v22 row_ror:12 row_mask:0xf bank_mask:0xf
    v_add_f32_dpp v36, v21, v20 row_ror:12 row_mask:0xf bank_mask:0xf
    v_add_f32_dpp v14, v39, v38 row_ror:8 row_mask:0xf bank_mask:0x8
    v_mfma_f32_16x16x32_bf16 v[32:35], v[164:167], v[16:19], 0
    v_add_f32_dpp v39, v24, v27 row_ror:12 row_mask:0xf bank_mask:0xf
    v_add_f32_dpp v38, v26, v25 row_ror:12 row_mask:0xf bank_mask:0xf
    v_add_f32_dpp v15, v37, v36 row_ror:8 row_mask:0xf bank_mask:0x1
    s_nop 0
    v_add_f32_dpp v37, v29, v28 row_ror:12 row_mask:0xf bank_mask:0xf
    v_add_f32_dpp v36, v31, v30 row_ror:12 row_mask:0xf bank_mask:0xf
    v_add_f32_dpp v15, v39, v38 row_ror:8 row_mask:0xf bank_mask:0x2
    s_nop 0
    v_add_f32_dpp v39, v34, v33 row_ror:12 row_mask:0xf bank_mask:0xf
    v_add_f32_dpp v38, v32, v35 row_ror:12 row_mask:0xf bank_mask:0xf
    v_add_f32_dpp v15, v37, v36 row_ror:8 row_mask:0xf bank_mask:0x4
    s_nop 1
    v_add_f32_dpp v15, v39, v38 row_ror:8 row_mask:0xf bank_mask:0x8
    s_add_u32 s74, s55, 155648
    s_and_b32 s74, s74, 0x3ffff
    s_cbranch_vccnz L_pc_36
    s_waitcnt vmcnt(4)
L_pc_36:
    s_waitcnt vmcnt(5)
    buffer_load_dwordx4 v[52:55], v4, s[36:39], s74 offen nt
    v_cvt_pk_bf16_f32 v8, 0, v8
    v_cvt_pk_bf16_f32 v9, 0, v9
    v_cvt_pk_bf16_f32 v10, 0, v10
    v_cvt_pk_bf16_f32 v11, 0, v11
    v_cvt_pk_bf16_f32 v12, 0, v12
    v_cvt_pk_bf16_f32 v13, 0, v13
    v_cvt_pk_bf16_f32 v14, 0, v14
    v_cvt_pk_bf16_f32 v15, 0, v15
    v_mul_f32 v8, 0x3db504f3, v8
    v_mul_f32 v9, 0x3db504f3, v9
    v_mul_f32 v10, 0x3db504f3, v10
    v_mul_f32 v11, 0x3db504f3, v11
    v_mul_f32 v12, 0x3db504f3, v12
    v_mul_f32 v13, 0x3db504f3, v13
    v_mul_f32 v14, 0x3db504f3, v14
    v_mul_f32 v15, 0x3db504f3, v15
    v_cvt_pk_bf16_f32 v8, 0, v8
    v_cvt_pk_bf16_f32 v9, 0, v9
    v_cvt_pk_bf16_f32 v10, 0, v10
    v_cvt_pk_bf16_f32 v11, 0, v11
    v_cvt_pk_bf16_f32 v12, 0, v12
    v_cvt_pk_bf16_f32 v13, 0, v13
    v_cvt_pk_bf16_f32 v14, 0, v14
    v_cvt_pk_bf16_f32 v15, 0, v15
    v_max3_f32 v20, v8, v9, v10
    v_max3_f32 v21, v11, v12, v13
    v_max3_f32 v20, v20, v14, v15
    v_max_f32 v20, v20, v21
    s_nop 1
    v_max_f32_dpp v20, v20, v20 row_ror:4 row_mask:0xf bank_mask:0xf
    s_nop 1
    v_max_f32_dpp v20, v20, v20 row_ror:8 row_mask:0xf bank_mask:0xf
    v_mov_b32 v21, v20
    s_nop 1
    v_permlane16_swap_b32 v20, v21
    v_max_f32 v20, v20, v21
    v_mov_b32 v21, v20
    s_nop 1
    v_permlane32_swap_b32 v20, v21
    v_max_f32 v20, v20, v21
    v_sub_f32 v24, v8, v20
    v_sub_f32 v25, v9, v20
    v_sub_f32 v26, v10, v20
    v_sub_f32 v27, v11, v20
    v_sub_f32 v28, v12, v20
    v_sub_f32 v29, v13, v20
    v_sub_f32 v30, v14, v20
    v_sub_f32 v31, v15, v20
    v_mul_f32 v24, 0x3fb8aa3b, v24
    v_mul_f32 v25, 0x3fb8aa3b, v25
    v_mul_f32 v26, 0x3fb8aa3b, v26
    v_mul_f32 v27, 0x3fb8aa3b, v27
    v_mul_f32 v28, 0x3fb8aa3b, v28
    v_mul_f32 v29, 0x3fb8aa3b, v29
    v_mul_f32 v30, 0x3fb8aa3b, v30
    v_mul_f32 v31, 0x3fb8aa3b, v31
    v_exp_f32 v24, v24
    v_exp_f32 v25, v25
    v_exp_f32 v26, v26
    v_exp_f32 v27, v27
    v_exp_f32 v28, v28
    v_exp_f32 v29, v29
    v_exp_f32 v30, v30
    v_exp_f32 v31, v31
    v_add_f32 v24, v24, v28
    v_add_f32 v25, v25, v29
    v_add_f32 v26, v26, v30
    v_add_f32 v27, v27, v31
    v_add_f32 v24, v24, v26
    v_add_f32 v25, v25, v27
    v_add_f32 v22, v24, v25
    s_nop 1
    v_add_f32_dpp v22, v22, v22 row_ror:4 row_mask:0xf bank_mask:0xf
    s_nop 1
    v_add_f32_dpp v22, v22, v22 row_ror:8 row_mask:0xf bank_mask:0xf
    v_mov_b32 v21, v22
    s_nop 1
    v_permlane16_swap_b32 v22, v21
    v_add_f32 v22, v22, v21
    v_mov_b32 v21, v22
    s_nop 1
    v_permlane32_swap_b32 v22, v21
    v_add_f32 v22, v22, v21
    v_mov_b32 v21, v22
    s_lshl_b32 s74, s3, 5
    s_add_u32 s74, s74, 140672
    v_lshl_add_u32 v5, v0, 3, s74
    s_mov_b64 exec, 0xf
    ds_write_b64 v5, v[20:21]
    s_mov_b64 exec, -1
    v_mov_b32 v6, 140568
    v_mov_b32 v7, 1
    s_mov_b64 exec, 1
    ds_add_u32 v6, v7
    s_mov_b64 exec, -1
    s_mov_b32 s74, 0x1000
    s_lshl_b32 s73, s61, 2
    s_lshr_b32 s57, s74, s73
    s_and_b32 s57, s57, 0xf
    s_mov_b32 s74, 3
    s_lshr_b32 s74, s74, s61
    s_and_b32 s74, s74, 1
    s_and_b32 s73, s64, 7
    s_cmp_eq_u32 s73, 3
    s_cselect_b32 s74, s74, 0
    s_or_b32 s57, s57, s74
    s_cmp_lg_u32 s57, 0
    s_cselect_b64 s[78:79], -1, 0
    s_mov_b64 vcc, s[78:79]
    s_cmp_ge_u32 s56, 131072
    s_cbranch_scc1 L_v1done
L_v1b:
    s_mov_b32 m0, s58
    s_add_u32 s74, s55, s56
    s_and_b32 s74, s74, 0x3ffff
    s_cbranch_vccnz L_pc_37
    s_waitcnt vmcnt(2)
L_pc_37:
    s_waitcnt vmcnt(3)
    buffer_load_dwordx4 v4, s[36:39], s74 offen nt lds
    s_add_u32 s58, s58, 1024
    s_add_u32 s56, s56, 8192
    s_cmp_lt_u32 s56, 131072
    s_cbranch_scc1 L_v1b
L_v1done:
    s_add_u32 s74, s55, 163840
    s_and_b32 s74, s74, 0x3ffff
    s_cbranch_vccnz L_pc_38
    s_waitcnt vmcnt(2)
L_pc_38:
    s_waitcnt vmcnt(3)
    buffer_load_dwordx4 v[56:59], v4, s[36:39], s74 offen nt
    v_mov_b32 v3, 140596
    v_mov_b32 v7, 1
    s_mov_b64 exec, 1
    ds_write_b32 v3, v7
    s_mov_b64 exec, -1
    s_add_u32 s74, s55, 172032
    s_and_b32 s74, s74, 0x3ffff
    s_cbranch_vccnz L_pc_39
    s_waitcnt vmcnt(2)
L_pc_39:
    s_waitcnt vmcnt(3)
    buffer_load_dwordx4 v[60:63], v4, s[36:39], s74 offen nt
    s_add_u32 s74, s55, 180224
    s_and_b32 s74, s74, 0x3ffff
    s_cbranch_vccnz L_pc_40
    s_waitcnt vmcnt(4)
L_pc_40:
    s_waitcnt vmcnt(5)
    buffer_load_dwordx4 v[64:67], v4, s[36:39], s74 offen nt
    s_add_u32 s74, s55, 188416
    s_and_b32 s74, s74, 0x3ffff
    s_cbranch_vccnz L_pc_41
    s_waitcnt vmcnt(4)
L_pc_41:
    s_waitcnt vmcnt(5)
    buffer_load_dwordx4 v[68:71], v4, s[36:39], s74 offen nt
    s_add_u32 s74, s55, 196608
    s_and_b32 s74, s74, 0x3ffff
    s_cbranch_vccnz L_pc_42
    s_waitcnt vmcnt(4)
L_pc_42:
    s_waitcnt vmcnt(5)
    buffer_load_dwordx4 v[72:75], v4, s[36:39], s74 offen nt
    s_add_u32 s74, s55, 204800
    s_and_b32 s74, s74, 0x3ffff
    s_cbranch_vccnz L_pc_43
    s_waitcnt vmcnt(4)
L_pc_43:
    s_waitcnt vmcnt(5)
    buffer_load_dwordx4 v[76:79], v4, s[36:39], s74 offen nt
    s_setprio 3
    v_lshl_add_u32 v5, v0, 4, s75
    v_and_b32 v6, 3, v0
    v_lshlrev_b32 v6, 3, v6
    v_add_u32 v6, 140608, v6
    s_waitcnt vmcnt(6)
    ds_read_b128 v[104:107], v5 offset:0
    ds_read_b128 v[108:111], v5 offset:1024
    ds_read_b128 v[112:115], v5 offset:2048
    ds_read_b128 v[116:119], v5 offset:3072
    ds_read_b128 v[120:123], v5 offset:4096
    ds_read_b128 v[124:127], v5 offset:5120
    ds_read_b128 v[128:131], v5 offset:6144
    ds_read_b128 v[132:135], v5 offset:7168
    v_mov_b32 v20, 0
    v_mov_b32 v21, 0
    v_mov_b32 v22, 0
    v_mov_b32 v23, 0
    v_mov_b32 v24, 0
    v_mov_b32 v25, 0
    v_mov_b32 v26, 0
    v_mov_b32 v27, 0
    v_mov_b32 v28, 0
    v_mov_b32 v29, 0
    v_mov_b32 v30, 0
    v_mov_b32 v31, 0
    v_mov_b32 v32, 0
    v_mov_b32 v33, 0
    v_mov_b32 v34, 0
    v_mov_b32 v35, 0
    v_mov_b32 v7, 140576
    s_mov_b32 s72, 64000000
L_lw_44:
    ds_read_b32 v16, v7
    s_waitcnt lgkmcnt(0)
    v_cmp_ne_u32 vcc, 1, v16
    s_nop 0
    s_cbranch_vccz L_lwdone_45
    s_sleep 1
    s_sub_u32 s72, s72, 1
    s_cmp_lg_u32 s72, 0
    s_cbranch_scc1 L_lw_44
L_lwdone_45:
    ds_read_b64 v[16:17], v6
    s_waitcnt lgkmcnt(0)
    v_sub_f32 v8, v8, v16
    v_sub_f32 v9, v9, v16
    v_sub_f32 v10, v10, v16
    v_sub_f32 v11, v11, v16
    v_sub_f32 v12, v12, v16
    v_sub_f32 v13, v13, v16
    v_sub_f32 v14, v14, v16
    v_sub_f32 v15, v15, v16
    v_mul_f32 v8, 0x3fb8aa3b, v8
    v_mul_f32 v9, 0x3fb8aa3b, v9
    v_mul_f32 v10, 0x3fb8aa3b, v10
    v_mul_f32 v11, 0x3fb8aa3b, v11
    v_mul_f32 v12, 0x3fb8aa3b, v12
    v_mul_f32 v13, 0x3fb8aa3b, v13
    v_mul_f32 v14, 0x3fb8aa3b, v14
    v_mul_f32 v15, 0x3fb8aa3b, v15
    v_exp_f32 v8, v8
    v_exp_f32 v9, v9
    v_exp_f32 v10, v10
    v_exp_f32 v11, v11
    v_exp_f32 v12, v12
    v_exp_f32 v13, v13
    v_exp_f32 v14, v14
    v_exp_f32 v15, v15
    s_mov_b64 vcc, s[78:79]
    s_add_u32 s74, s55, 212992
    s_and_b32 s74, s74, 0x3ffff
    s_cbranch_vccnz L_pc_47
    s_waitcnt vmcnt(4)
L_pc_47:
    s_waitcnt vmcnt(5)
    buffer_load_dwordx4 v[80:83], v4, s[36:39], s74 offen nt
L_ll_46:
    v_mul_f32 v8, v8, v17
    v_mul_f32 v9, v9, v17
    v_mul_f32 v10, v10, v17
    v_mul_f32 v11, v11, v17
    v_mul_f32 v12, v12, v17
    v_mul_f32 v13, v13, v17
    v_mul_f32 v14, v14, v17
    v_mul_f32 v15, v15, v17
    v_mov_b32_dpp v136, v8 row_ror:12 row_mask:0xf bank_mask:0xf
    v_mov_b32_dpp v137, v9 row_ror:12 row_mask:0xf bank_mask:0xf
    v_mov_b32_dpp v138, v10 row_ror:12 row_mask:0xf bank_mask:0xf
    v_mov_b32_dpp v139, v11 row_ror:12 row_mask:0xf bank_mask:0xf
    v_mov_b32_dpp v140, v12 row_ror:12 row_mask:0xf bank_mask:0xf
    v_mov_b32_dpp v141, v13 row_ror:12 row_mask:0xf bank_mask:0xf
    v_mov_b32_dpp v142, v14 row_ror:12 row_mask:0xf bank_mask:0xf
    v_mov_b32_dpp v143, v15 row_ror:12 row_mask:0xf bank_mask:0xf
    v_cvt_pk_bf16_f32 v8, v8, v136
    v_cvt_pk_bf16_f32 v9, v9, v137
    v_cvt_pk_bf16_f32 v10, v10, v138
    v_cvt_pk_bf16_f32 v11, v11, v139
    v_cvt_pk_bf16_f32 v12, v12, v140
    v_cvt_pk_bf16_f32 v13, v13, v141
    v_cvt_pk_bf16_f32 v14, v14, v142
    v_cvt_pk_bf16_f32 v15, v15, v143
    s_mov_b64 vcc, s[78:79]
    s_add_u32 s74, s55, 221184
    s_and_b32 s74, s74, 0x3ffff
    s_cbranch_vccnz L_pc_49
    s_waitcnt vmcnt(4)
L_pc_49:
    s_waitcnt vmcnt(5)
    buffer_load_dwordx4 v[84:87], v4, s[36:39], s74 offen nt
L_ll_48:
    v_mov_b32_dpp v20, v8 quad_perm:[0,1,2,3] row_mask:0xf bank_mask:0x1
    v_mov_b32_dpp v21, v8 row_ror:8 row_mask:0xf bank_mask:0x1
    v_mov_b32_dpp v22, v9 quad_perm:[0,1,2,3] row_mask:0xf bank_mask:0x1
    v_mov_b32_dpp v23, v9 row_ror:8 row_mask:0xf bank_mask:0x1
    v_mov_b32_dpp v24, v8 row_ror:4 row_mask:0xf bank_mask:0x2
    v_mov_b32_dpp v25, v8 row_ror:12 row_mask:0xf bank_mask:0x2
    v_mov_b32_dpp v26, v9 row_ror:4 row_mask:0xf bank_mask:0x2
    v_mov_b32_dpp v27, v9 row_ror:12 row_mask:0xf bank_mask:0x2
    v_mov_b32_dpp v28, v8 row_ror:8 row_mask:0xf bank_mask:0x4
    v_mov_b32_dpp v29, v8 quad_perm:[0,1,2,3] row_mask:0xf bank_mask:0x4
    v_mov_b32_dpp v30, v9 row_ror:8 row_mask:0xf bank_mask:0x4
    v_mov_b32_dpp v31, v9 quad_perm:[0,1,2,3] row_mask:0xf bank_mask:0x4
    v_mov_b32_dpp v32, v8 row_ror:12 row_mask:0xf bank_mask:0x8
    v_mov_b32_dpp v33, v8 row_ror:4 row_mask:0xf bank_mask:0x8
    v_mov_b32_dpp v34, v9 row_ror:12 row_mask:0xf bank_mask:0x8
    v_mov_b32_dpp v35, v9 row_ror:4 row_mask:0xf bank_mask:0x8
    v_perm_b32 v136, v108, v104, s70
    v_perm_b32 v137, v116, v112, s70
    v_perm_b32 v138, v124, v120, s70
    v_perm_b32 v139, v132, v128, s70
    v_perm_b32 v140, v108, v104, s71
    v_perm_b32 v141, v116, v112, s71
    v_perm_b32 v142, v124, v120, s71
    v_perm_b32 v143, v132, v128, s71
    v_mfma_f32_16x16x32_bf16 v[16:19], v[20:23], v[136:139], 0
    v_perm_b32 v144, v109, v105, s70
    v_perm_b32 v145, v117, v113, s70
    v_perm_b32 v146, v125, v121, s70
    v_perm_b32 v147, v133, v129, s70
    v_mfma_f32_16x16x32_bf16 v[16:19], v[24:27], v[140:143], v[16:19]
    v_perm_b32 v148, v109, v105, s71
    v_perm_b32 v149, v117, v113, s71
    v_perm_b32 v150, v125, v121, s71
    v_perm_b32 v151, v133, v129, s71
    v_mfma_f32_16x16x32_bf16 v[16:19], v[28:31], v[144:147], v[16:19]
    v_perm_b32 v152, v110, v106, s70
    v_perm_b32 v153, v118, v114, s70
    v_perm_b32 v154, v126, v122, s70
    v_perm_b32 v155, v134, v130, s70
    v_mfma_f32_16x16x32_bf16 v[16:19], v[32:35], v[148:151], v[16:19]
    v_perm_b32 v156, v110, v106, s71
    v_perm_b32 v157, v118, v114, s71
    v_perm_b32 v158, v126, v122, s71
    v_perm_b32 v159, v134, v130, s71
    v_mfma_f32_16x16x32_bf16 v[36:39], v[20:23], v[152:155], 0
    v_perm_b32 v160, v111, v107, s70
    v_perm_b32 v161, v119, v115, s70
    v_perm_b32 v162, v127, v123, s70
    v_perm_b32 v163, v135, v131, s70
    v_mfma_f32_16x16x32_bf16 v[36:39], v[24:27], v[156:159], v[36:39]
    v_perm_b32 v164, v111, v107, s71
    v_perm_b32 v165, v119, v115, s71
    v_perm_b32 v166, v127, v123, s71
    v_perm_b32 v167, v135, v131, s71
    v_mfma_f32_16x16x32_bf16 v[36:39], v[28:31], v[160:163], v[36:39]
    s_nop 0
    v_mfma_f32_16x16x32_bf16 v[36:39], v[32:35], v[164:167], v[36:39]
    ds_read_b128 v[104:107], v5 offset:8192
    ds_read_b128 v[108:111], v5 offset:9216
    ds_read_b128 v[112:115], v5 offset:10240
    ds_read_b128 v[116:119], v5 offset:11264
    ds_read_b128 v[120:123], v5 offset:12288
    ds_read_b128 v[124:127], v5 offset:13312
    ds_read_b128 v[128:131], v5 offset:14336
    ds_read_b128 v[132:135], v5 offset:15360
    s_mov_b64 vcc, s[78:79]
    s_add_u32 s74, s55, 229376
    s_and_b32 s74, s74, 0x3ffff
    s_cbranch_vccnz L_pc_51
    s_waitcnt vmcnt(4)
L_pc_51:
    s_waitcnt vmcnt(5)
    buffer_load_dwordx4 v[88:91], v4, s[36:39], s74 offen nt
L_ll_50:
    s_waitcnt lgkmcnt(0)
    v_mov_b32_dpp v20, v10 quad_perm:[0,1,2,3] row_mask:0xf bank_mask:0x1
    v_mov_b32_dpp v21, v10 row_ror:8 row_mask:0xf bank_mask:0x1
    v_mov_b32_dpp v22, v11 quad_perm:[0,1,2,3] row_mask:0xf bank_mask:0x1
    v_mov_b32_dpp v23, v11 row_ror:8 row_mask:0xf bank_mask:0x1
    v_mov_b32_dpp v24, v10 row_ror:4 row_mask:0xf bank_mask:0x2
    v_mov_b32_dpp v25, v10 row_ror:12 row_mask:0xf bank_mask:0x2
    v_mov_b32_dpp v26, v11 row_ror:4 row_mask:0xf bank_mask:0x2
    v_mov_b32_dpp v27, v11 row_ror:12 row_mask:0xf bank_mask:0x2
    v_mov_b32_dpp v28, v10 row_ror:8 row_mask:0xf bank_mask:0x4
    v_mov_b32_dpp v29, v10 quad_perm:[0,1,2,3] row_mask:0xf bank_mask:0x4
    v_mov_b32_dpp v30, v11 row_ror:8 row_mask:0xf bank_mask:0x4
    v_mov_b32_dpp v31, v11 quad_perm:[0,1,2,3] row_mask:0xf bank_mask:0x4
    v_mov_b32_dpp v32, v10 row_ror:12 row_mask:0xf bank_mask:0x8
    v_mov_b32_dpp v33, v10 row_ror:4 row_mask:0xf bank_mask:0x8
    v_mov_b32_dpp v34, v11 row_ror:12 row_mask:0xf bank_mask:0x8
    v_mov_b32_dpp v35, v11 row_ror:4 row_mask:0xf bank_mask:0x8
    v_perm_b32 v136, v108, v104, s70
    v_perm_b32 v137, v116, v112, s70
    v_perm_b32 v138, v124, v120, s70
    v_perm_b32 v139, v132, v128, s70
    v_perm_b32 v140, v108, v104, s71
    v_perm_b32 v141, v116, v112, s71
    v_perm_b32 v142, v124, v120, s71
    v_perm_b32 v143, v132, v128, s71
    v_mfma_f32_16x16x32_bf16 v[16:19], v[20:23], v[136:139], v[16:19]
    v_perm_b32 v144, v109, v105, s70
    v_perm_b32 v145, v117, v113, s70
    v_perm_b32 v146, v125, v121, s70
    v_perm_b32 v147, v133, v129, s70
    v_mfma_f32_16x16x32_bf16 v[16:19], v[24:27], v[140:143], v[16:19]
    v_perm_b32 v148, v109, v105, s71
    v_perm_b32 v149, v117, v113, s71
    v_perm_b32 v150, v125, v121, s71
    v_perm_b32 v151, v133, v129, s71
    v_mfma_f32_16x16x32_bf16 v[16:19], v[28:31], v[144:147], v[16:19]
    v_perm_b32 v152, v110, v106, s70
    v_perm_b32 v153, v118, v114, s70
    v_perm_b32 v154, v126, v122, s70
    v_perm_b32 v155, v134, v130, s70
    v_mfma_f32_16x16x32_bf16 v[16:19], v[32:35], v[148:151], v[16:19]
    v_perm_b32 v156, v110, v106, s71
    v_perm_b32 v157, v118, v114, s71
    v_perm_b32 v158, v126, v122, s71
    v_perm_b32 v159, v134, v130, s71
    v_mfma_f32_16x16x32_bf16 v[36:39], v[20:23], v[152:155], v[36:39]
    v_perm_b32 v160, v111, v107, s70
    v_perm_b32 v161, v119, v115, s70
    v_perm_b32 v162, v127, v123, s70
    v_perm_b32 v163, v135, v131, s70
    v_mfma_f32_16x16x32_bf16 v[36:39], v[24:27], v[156:159], v[36:39]
    v_perm_b32 v164, v111, v107, s71
    v_perm_b32 v165, v119, v115, s71
    v_perm_b32 v166, v127, v123, s71
    v_perm_b32 v167, v135, v131, s71
    v_mfma_f32_16x16x32_bf16 v[36:39], v[28:31], v[160:163], v[36:39]
    s_nop 0
    v_mfma_f32_16x16x32_bf16 v[36:39], v[32:35], v[164:167], v[36:39]
    s_mov_b64 vcc, s[78:79]
    s_add_u32 s74, s55, 237568
    s_and_b32 s74, s74, 0x3ffff
    s_cbranch_vccnz L_pc_53
    s_waitcnt vmcnt(4)
L_pc_53:
    s_waitcnt vmcnt(5)
    buffer_load_dwordx4 v[92:95], v4, s[36:39], s74 offen nt
L_ll_52:
    s_mov_b64 vcc, s[78:79]
    s_add_u32 s74, s55, 245760
    s_and_b32 s74, s74, 0x3ffff
    s_cbranch_vccnz L_pc_55
    s_waitcnt vmcnt(4)
L_pc_55:
    s_waitcnt vmcnt(5)
    buffer_load_dwordx4 v[96:99], v4, s[36:39], s74 offen nt
L_ll_54:
    s_mov_b64 vcc, s[78:79]
    s_add_u32 s74, s55, 253952
    s_and_b32 s74, s74, 0x3ffff
    s_cbranch_vccnz L_pc_57
    s_waitcnt vmcnt(4)
L_pc_57:
    s_waitcnt vmcnt(5)
    buffer_load_dwordx4 v[100:103], v4, s[36:39], s74 offen nt
    v_mov_b32 v3, 140580
    v_mov_b32 v7, 1
    s_mov_b64 exec, 1
    ds_add_u32 v3, v7
    s_mov_b64 exec, -1
L_ll_56:
    s_waitcnt vmcnt(8)
    v_mov_b32_dpp v20, v12 quad_perm:[0,1,2,3] row_mask:0xf bank_mask:0x1
    v_mov_b32_dpp v21, v12 row_ror:8 row_mask:0xf bank_mask:0x1
    v_mov_b32_dpp v22, v13 quad_perm:[0,1,2,3] row_mask:0xf bank_mask:0x1
    v_mov_b32_dpp v23, v13 row_ror:8 row_mask:0xf bank_mask:0x1
    v_mov_b32_dpp v24, v12 row_ror:4 row_mask:0xf bank_mask:0x2
    v_mov_b32_dpp v25, v12 row_ror:12 row_mask:0xf bank_mask:0x2
    v_mov_b32_dpp v26, v13 row_ror:4 row_mask:0xf bank_mask:0x2
    v_mov_b32_dpp v27, v13 row_ror:12 row_mask:0xf bank_mask:0x2
    v_mov_b32_dpp v28, v12 row_ror:8 row_mask:0xf bank_mask:0x4
    v_mov_b32_dpp v29, v12 quad_perm:[0,1,2,3] row_mask:0xf bank_mask:0x4
    v_mov_b32_dpp v30, v13 row_ror:8 row_mask:0xf bank_mask:0x4
    v_mov_b32_dpp v31, v13 quad_perm:[0,1,2,3] row_mask:0xf bank_mask:0x4
    v_mov_b32_dpp v32, v12 row_ror:12 row_mask:0xf bank_mask:0x8
    v_mov_b32_dpp v33, v12 row_ror:4 row_mask:0xf bank_mask:0x8
    v_mov_b32_dpp v34, v13 row_ror:12 row_mask:0xf bank_mask:0x8
    v_mov_b32_dpp v35, v13 row_ror:4 row_mask:0xf bank_mask:0x8
    v_perm_b32 v136, v44, v40, s70
    v_perm_b32 v137, v52, v48, s70
    v_perm_b32 v138, v60, v56, s70
    v_perm_b32 v139, v68, v64, s70
    v_perm_b32 v140, v44, v40, s71
    v_perm_b32 v141, v52, v48, s71
    v_perm_b32 v142, v60, v56, s71
    v_perm_b32 v143, v68, v64, s71
    v_mfma_f32_16x16x32_bf16 v[16:19], v[20:23], v[136:139], v[16:19]
    v_perm_b32 v144, v45, v41, s70
    v_perm_b32 v145, v53, v49, s70
    v_perm_b32 v146, v61, v57, s70
    v_perm_b32 v147, v69, v65, s70
    v_mfma_f32_16x16x32_bf16 v[16:19], v[24:27], v[140:143], v[16:19]
    v_perm_b32 v148, v45, v41, s71
    v_perm_b32 v149, v53, v49, s71
    v_perm_b32 v150, v61, v57, s71
    v_perm_b32 v151, v69, v65, s71
    v_mfma_f32_16x16x32_bf16 v[16:19], v[28:31], v[144:147], v[16:19]
    v_perm_b32 v152, v46, v42, s70
    v_perm_b32 v153, v54, v50, s70
    v_perm_b32 v154, v62, v58, s70
    v_perm_b32 v155, v70, v66, s70
    v_mfma_f32_16x16x32_bf16 v[16:19], v[32:35], v[148:151], v[16:19]
    v_perm_b32 v156, v46, v42, s71
    v_perm_b32 v157, v54, v50, s71
    v_perm_b32 v158, v62, v58, s71
    v_perm_b32 v159, v70, v66, s71
    v_mfma_f32_16x16x32_bf16 v[36:39], v[20:23], v[152:155], v[36:39]
    v_perm_b32 v160, v47, v43, s70
    v_perm_b32 v161, v55, v51, s70
    v_perm_b32 v162, v63, v59, s70
    v_perm_b32 v163, v71, v67, s70
    v_mfma_f32_16x16x32_bf16 v[36:39], v[24:27], v[156:159], v[36:39]
    v_perm_b32 v164, v47, v43, s71
    v_perm_b32 v165, v55, v51, s71
    v_perm_b32 v166, v63, v59, s71
    v_perm_b32 v167, v71, v67, s71
    v_mfma_f32_16x16x32_bf16 v[36:39], v[28:31], v[160:163], v[36:39]
    s_nop 0
    v_mfma_f32_16x16x32_bf16 v[36:39], v[32:35], v[164:167], v[36:39]
    v_mov_b32_dpp v20, v14 quad_perm:[0,1,2,3] row_mask:0xf bank_mask:0x1
    v_mov_b32_dpp v21, v14 row_ror:8 row_mask:0xf bank_mask:0x1
    v_mov_b32_dpp v22, v15 quad_perm:[0,1,2,3] row_mask:0xf bank_mask:0x1
    v_mov_b32_dpp v23, v15 row_ror:8 row_mask:0xf bank_mask:0x1
    v_mov_b32_dpp v24, v14 row_ror:4 row_mask:0xf bank_mask:0x2
    v_mov_b32_dpp v25, v14 row_ror:12 row_mask:0xf bank_mask:0x2
    v_mov_b32_dpp v26, v15 row_ror:4 row_mask:0xf bank_mask:0x2
    v_mov_b32_dpp v27, v15 row_ror:12 row_mask:0xf bank_mask:0x2
    v_mov_b32_dpp v28, v14 row_ror:8 row_mask:0xf bank_mask:0x4
    v_mov_b32_dpp v29, v14 quad_perm:[0,1,2,3] row_mask:0xf bank_mask:0x4
    v_mov_b32_dpp v30, v15 row_ror:8 row_mask:0xf bank_mask:0x4
    v_mov_b32_dpp v31, v15 quad_perm:[0,1,2,3] row_mask:0xf bank_mask:0x4
    v_mov_b32_dpp v32, v14 row_ror:12 row_mask:0xf bank_mask:0x8
    v_mov_b32_dpp v33, v14 row_ror:4 row_mask:0xf bank_mask:0x8
    v_mov_b32_dpp v34, v15 row_ror:12 row_mask:0xf bank_mask:0x8
    v_mov_b32_dpp v35, v15 row_ror:4 row_mask:0xf bank_mask:0x8
    v_mov_b32 v6, 140584
    v_mov_b32 v7, 1
    s_lshl_b32 s74, s3, 10
    v_lshl_add_u32 v40, v0, 4, s74
    v_add_u32 v41, 0x10000, v40
    s_lshl_b32 s68, s66, 15
    s_bfe_u32 s74, s62, 0x10002
    s_lshl_b32 s74, s74, 14
    s_add_u32 s68, s68, s74
    s_lshl_b32 s74, s65, 6
    s_add_u32 s68, s68, s74
    s_and_b32 s74, s62, 3
    s_lshl_b32 s74, s74, 4
    s_add_u32 s68, s68, s74
    s_add_u32 s67, s68, 1310720
    v_lshrrev_b32 v44, 1, v0
    v_lshlrev_b32 v44, 8, v44
    v_and_b32 v45, 1, v0
    v_lshl_add_u32 v44, v45, 3, v44
    s_lshl_b32 s74, s3, 13
    v_add_u32 v44, s74, v44
    s_lshr_b32 s73, s62, 3
    s_lshl_b32 s73, s73, 7
    s_and_b32 s74, s62, 7
    s_lshl_b32 s74, s74, 2
    s_add_u32 s73, s73, s74
    s_lshl_b32 s74, s3, 5
    s_add_u32 s73, s73, s74
    s_add_u32 s73, s73, 196608
    v_mov_b32 v42, s73
    v_mov_b32 v43, s63
    s_add_u32 s68, s68, 262144
    s_waitcnt vmcnt(6)
    v_perm_b32 v136, v76, v72, s70
    v_perm_b32 v140, v76, v72, s71
    v_perm_b32 v144, v77, v73, s70
    v_perm_b32 v148, v77, v73, s71
    v_perm_b32 v152, v78, v74, s70
    v_perm_b32 v156, v78, v74, s71
    v_perm_b32 v160, v79, v75, s70
    v_perm_b32 v164, v79, v75, s71
    s_waitcnt vmcnt(4)
    v_perm_b32 v137, v84, v80, s70
    v_perm_b32 v141, v84, v80, s71
    v_perm_b32 v145, v85, v81, s70
    v_perm_b32 v149, v85, v81, s71
    v_perm_b32 v153, v86, v82, s70
    v_perm_b32 v157, v86, v82, s71
    v_perm_b32 v161, v87, v83, s70
    v_perm_b32 v165, v87, v83, s71
    s_waitcnt vmcnt(2)
    v_perm_b32 v138, v92, v88, s70
    v_perm_b32 v142, v92, v88, s71
    v_perm_b32 v146, v93, v89, s70
    v_perm_b32 v150, v93, v89, s71
    v_perm_b32 v154, v94, v90, s70
    v_perm_b32 v158, v94, v90, s71
    v_perm_b32 v162, v95, v91, s70
    v_perm_b32 v166, v95, v91, s71
    s_waitcnt vmcnt(0)
    v_perm_b32 v139, v100, v96, s70
    v_perm_b32 v143, v100, v96, s71
    v_perm_b32 v147, v101, v97, s70
    v_mfma_f32_16x16x32_bf16 v[16:19], v[20:23], v[136:139], v[16:19]
    v_perm_b32 v151, v101, v97, s71
    v_mfma_f32_16x16x32_bf16 v[16:19], v[24:27], v[140:143], v[16:19]
    v_perm_b32 v155, v102, v98, s70
    v_mfma_f32_16x16x32_bf16 v[16:19], v[28:31], v[144:147], v[16:19]
    v_perm_b32 v159, v102, v98, s71
    v_mfma_f32_16x16x32_bf16 v[16:19], v[32:35], v[148:151], v[16:19]
    v_perm_b32 v163, v103, v99, s70
    v_mfma_f32_16x16x32_bf16 v[36:39], v[20:23], v[152:155], v[36:39]
    v_perm_b32 v167, v103, v99, s71
    v_mfma_f32_16x16x32_bf16 v[36:39], v[24:27], v[156:159], v[36:39]
    v_mfma_f32_16x16x32_bf16 v[36:39], v[28:31], v[160:163], v[36:39]
    v_mfma_f32_16x16x32_bf16 v[36:39], v[32:35], v[164:167], v[36:39]
    s_nop 1
    ds_write_b128 v5, v[16:19]
    s_nop 4
    ds_write_b128 v5, v[36:39] offset:1024
    s_mov_b64 exec, 1
    ds_add_u32 v6, v7
    s_mov_b64 exec, -1
    s_cmp_ge_u32 s3, 2
    s_cbranch_scc1 L_kpost
    v_mov_b32 v6, 140584
    s_mov_b32 s72, 64000000
L_lw_58:
    ds_read_b32 v7, v6
    s_waitcnt lgkmcnt(0)
    v_cmp_ne_u32 vcc, 8, v7
    s_nop 0
    s_cbranch_vccz L_lwdone_59
    s_sub_u32 s72, s72, 1
    s_cmp_lg_u32 s72, 0
    s_cbranch_scc1 L_lw_58
L_lwdone_59:
    ds_read_b128 v[104:107], v40 offset:0
    ds_read_b128 v[108:111], v40 offset:16384
    ds_read_b128 v[112:115], v40 offset:32768
    ds_read_b128 v[116:119], v40 offset:49152
    ds_read_b128 v[120:123], v41 offset:0
    ds_read_b128 v[124:127], v41 offset:16384
    ds_read_b128 v[128:131], v41 offset:32768
    ds_read_b128 v[132:135], v41 offset:49152
    s_waitcnt lgkmcnt(6)
    v_pk_add_f32 v[104:105], v[104:105], v[108:109]
    v_pk_add_f32 v[106:107], v[106:107], v[110:111]
    s_waitcnt lgkmcnt(4)
    v_pk_add_f32 v[112:113], v[112:113], v[116:117]
    v_pk_add_f32 v[114:115], v[114:115], v[118:119]
    v_pk_add_f32 v[104:105], v[104:105], v[112:113]
    v_pk_add_f32 v[106:107], v[106:107], v[114:115]
    s_waitcnt lgkmcnt(2)
    v_pk_add_f32 v[120:121], v[120:121], v[124:125]
    v_pk_add_f32 v[122:123], v[122:123], v[126:127]
    s_waitcnt lgkmcnt(0)
    v_pk_add_f32 v[128:129], v[128:129], v[132:133]
    v_pk_add_f32 v[130:131], v[130:131], v[134:135]
    v_pk_add_f32 v[120:121], v[120:121], v[128:129]
    v_pk_add_f32 v[122:123], v[122:123], v[130:131]
    v_pk_add_f32 v[104:105], v[104:105], v[120:121]
    v_pk_add_f32 v[106:107], v[106:107], v[122:123]
    v_cvt_pk_bf16_f32 v104, v104, v105
    v_cvt_pk_bf16_f32 v105, v106, v107
    buffer_store_dwordx2 v[104:105], v44, s[40:43], s67 offen
    v_mov_b32 v6, 140572
    v_mov_b32 v7, 1
    s_mov_b64 exec, 1
    ds_add_u32 v6, v7
    s_mov_b64 exec, -1
    s_cmp_lg_u32 s61, 2
    s_cbranch_scc1 L_skc
    v_mov_b32 v8, 140588
    s_mov_b32 s72, 64000000
L_lw_60:
    ds_read_b32 v9, v8
    s_waitcnt lgkmcnt(0)
    v_cmp_ne_u32 vcc, 5, v9
    s_nop 0
    s_cbranch_vccz L_lwdone_61
    s_sleep 1
    s_sub_u32 s72, s72, 1
    s_cmp_lg_u32 s72, 0
    s_cbranch_scc1 L_lw_60
L_lwdone_61:
    ds_read_b32 v9, v8 offset:16
    s_waitcnt lgkmcnt(0)
    v_cmp_eq_u32 vcc, 0, v9
    s_nop 0
    s_cbranch_vccz L_kpost
    s_branch L_shc
L_skc:
    v_and_b32 v8, 7, v0
    v_lshlrev_b32 v8, 6, v8
    v_bfe_u32 v9, v0, 3, 2
    v_lshl_add_u32 v8, v9, 12, v8
    s_lshl_b32 s75, s66, 9
    s_add_u32 s75, s75, 131072
    buffer_load_dwordx2 v[10:11], v8, s[40:43], s75 offen sc1
    s_getreg_b32 s74, hwreg(HW_REG_XCC_ID)
    s_and_b32 s74, s74, 0xf
    s_waitcnt vmcnt(0)
    v_and_b32 v10, 0xffff, v10
    v_cmp_ne_u32 s[76:77], s74, v10
    v_cmp_ne_u32 vcc, s63, v11
    s_nop 0
    s_or_b64 vcc, vcc, s[76:77]
    s_cbranch_vccz L_kpost
L_shc:
    buffer_store_dwordx2 v[104:105], v44, s[40:43], s68 offen sc1
    s_waitcnt vmcnt(0)
    s_mov_b64 exec, 1
    buffer_store_dword v43, v42, s[40:43], 0 offen sc1
    s_mov_b64 exec, -1
L_kpost:
    s_setprio 0
    s_cmp_lg_u32 s61, 3
    s_cbranch_scc1 L_fin
L_kpost_f:
    s_lshl_b32 s74, s3, 10
    v_lshl_add_u32 v5, v0, 4, s74
    s_lshl_b32 s74, s3, 7
    v_lshl_add_u32 v43, v1, 3, s74
    v_lshl_add_u32 v7, v2, 10, v43
    v_lshlrev_b32 v40, 1, v7
    v_add_u32 v40, 4096, v40
    v_add_u32 v7, 142208, v7
    s_lshl_b32 s73, s64, 2
    s_add_u32 s73, s73, s3
    s_and_b32 s73, s73, 127
    v_and_b32 v45, 1, v2
    v_lshrrev_b32 v6, 1, v2
    v_lshl_add_u32 v45, v45, 1, v6
    s_lshl_b32 s74, s73, 2
    v_and_b32 v44, 3, v0
    v_add_u32 v44, s74, v44
    v_bfe_u32 v46, v0, 1, 1
    v_lshlrev_b32 v46, 3, v46
    v_lshl_add_u32 v46, v45, 13, v46
    s_lshl_b32 s59, s73, 4
    s_add_u32 s59, s59, 26624
    buffer_load_dwordx2 v[26:27], v46, s[40:43], s59 offen sc1
    v_mov_b32 v12, 140592
    s_mov_b32 s72, 64000000
L_lw_62:
    ds_read_b32 v13, v12
    s_waitcnt lgkmcnt(0)
    v_cmp_ne_u32 vcc, 3, v13
    s_nop 0
    s_cbranch_vccz L_lwdone_63
    s_sleep 1
    s_sub_u32 s72, s72, 1
    s_cmp_lg_u32 s72, 0
    s_cbranch_scc1 L_lw_62
L_lwdone_63:
    ds_read_b64 v[12:13], v7 offset:0
    ds_read_b64 v[14:15], v7 offset:4096
    ds_read_b64 v[16:17], v7 offset:8192
    ds_read_b64 v[18:19], v7 offset:12288
    s_waitcnt lgkmcnt(0)
    v_lshlrev_b32 v28, 16, v12
    v_and_b32 v29, 0xffff0000, v12
    v_lshlrev_b32 v30, 16, v13
    v_and_b32 v31, 0xffff0000, v13
    v_lshlrev_b32 v32, 16, v14
    v_and_b32 v33, 0xffff0000, v14
    v_lshlrev_b32 v34, 16, v15
    v_and_b32 v35, 0xffff0000, v15
    v_lshlrev_b32 v36, 16, v16
    v_and_b32 v37, 0xffff0000, v16
    v_lshlrev_b32 v38, 16, v17
    v_and_b32 v39, 0xffff0000, v17
    v_lshlrev_b32 v8, 16, v18
    v_and_b32 v9, 0xffff0000, v18
    v_lshlrev_b32 v10, 16, v19
    v_and_b32 v11, 0xffff0000, v19
    s_mov_b32 s52, 786432
    s_mov_b32 s53, 802816
    s_mov_b32 s54, 819200
    s_mov_b32 s55, 835584
    v_add_u32 v6, 8192, v5
    s_lshl_b32 s74, s3, 3
    s_add_u32 s74, s74, 140928
    v_lshl_add_u32 v41, v2, 6, s74
    v_and_b32 v42, 7, v0
    v_lshlrev_b32 v42, 3, v42
    v_lshl_add_u32 v42, v2, 6, v42
    v_add_u32 v42, 140928, v42
    v_mul_u32_u24 v12, 1088, v2
    v_add_u32 v43, v12, v43
    v_add_u32 v43, 132096, v43
    v_mov_b32 v12, 140588
    s_mov_b32 s72, 64000000
L_lw_64:
    ds_read_b32 v13, v12
    s_waitcnt lgkmcnt(0)
    v_cmp_ne_u32 vcc, 4, v13
    s_nop 0
    s_cbranch_vccz L_lwdone_65
    s_sleep 1
    s_sub_u32 s72, s72, 1
    s_cmp_lg_u32 s72, 0
    s_cbranch_scc1 L_lw_64
L_lwdone_65:
    s_mov_b32 s72, 1000000
    s_mov_b32 s73, 0
L_gs_66:
    s_bitcmp1_b32 s73, 0
    s_cbranch_scc1 L_gsk_69
    buffer_load_dwordx4 v[48:51], v5, s[40:43], s52 offen sc1
L_gsk_69:
    s_bitcmp1_b32 s73, 1
    s_cbranch_scc1 L_gsk_70
    buffer_load_dwordx4 v[52:55], v6, s[40:43], s52 offen sc1
L_gsk_70:
    s_bitcmp1_b32 s73, 2
    s_cbranch_scc1 L_gsk_71
    buffer_load_dwordx4 v[56:59], v5, s[40:43], s53 offen sc1
L_gsk_71:
    s_bitcmp1_b32 s73, 3
    s_cbranch_scc1 L_gsk_72
    buffer_load_dwordx4 v[60:63], v6, s[40:43], s53 offen sc1
L_gsk_72:
    s_bitcmp1_b32 s73, 4
    s_cbranch_scc1 L_gsk_73
    buffer_load_dwordx4 v[64:67], v5, s[40:43], s54 offen sc1
L_gsk_73:
    s_bitcmp1_b32 s73, 5
    s_cbranch_scc1 L_gsk_74
    buffer_load_dwordx4 v[68:71], v6, s[40:43], s54 offen sc1
L_gsk_74:
    s_bitcmp1_b32 s73, 6
    s_cbranch_scc1 L_gsk_75
    buffer_load_dwordx4 v[72:75], v5, s[40:43], s55 offen sc1
L_gsk_75:
    s_bitcmp1_b32 s73, 7
    s_cbranch_scc1 L_gsk_76
    buffer_load_dwordx4 v[76:79], v6, s[40:43], s55 offen sc1
L_gsk_76:
    s_waitcnt vmcnt(0)
    v_pk_add_f32 v[80:81], v[48:49], v[52:53]
    v_pk_add_f32 v[82:83], v[50:51], v[54:55]
    v_pk_add_f32 v[84:85], v[56:57], v[60:61]
    v_pk_add_f32 v[86:87], v[58:59], v[62:63]
    v_pk_add_f32 v[88:89], v[64:65], v[68:69]
    v_pk_add_f32 v[90:91], v[66:67], v[70:71]
    v_pk_add_f32 v[92:93], v[72:73], v[76:77]
    v_pk_add_f32 v[94:95], v[74:75], v[78:79]
    v_pk_add_f32 v[80:81], v[80:81], v[84:85]
    v_pk_add_f32 v[82:83], v[82:83], v[86:87]
    v_pk_add_f32 v[88:89], v[88:89], v[92:93]
    v_pk_add_f32 v[90:91], v[90:91], v[94:95]
    v_pk_add_f32 v[16:17], v[80:81], v[88:89]
    v_pk_add_f32 v[18:19], v[82:83], v[90:91]
    v_cmp_u_f32 s[76:77], v16, v17
    v_cmp_u_f32 vcc, v18, v19
    s_nop 0
    s_or_b64 vcc, vcc, s[76:77]
    s_cbranch_vccz L_gsdone_67
    s_bitcmp1_b32 s73, 0
    s_cbranch_scc1 L_gck_77
    v_max3_u32 v80, v48, v49, v50
    v_max_u32 v80, v80, v51
    v_cmp_eq_u32 vcc, -1, v80
    s_nop 0
    s_cmp_eq_u64 vcc, 0
    s_cselect_b32 s74, 1, 0
    s_or_b32 s73, s73, s74
L_gck_77:
    s_bitcmp1_b32 s73, 1
    s_cbranch_scc1 L_gck_78
    v_max3_u32 v80, v52, v53, v54
    v_max_u32 v80, v80, v55
    v_cmp_eq_u32 vcc, -1, v80
    s_nop 0
    s_cmp_eq_u64 vcc, 0
    s_cselect_b32 s74, 2, 0
    s_or_b32 s73, s73, s74
L_gck_78:
    s_bitcmp1_b32 s73, 2
    s_cbranch_scc1 L_gck_79
    v_max3_u32 v80, v56, v57, v58
    v_max_u32 v80, v80, v59
    v_cmp_eq_u32 vcc, -1, v80
    s_nop 0
    s_cmp_eq_u64 vcc, 0
    s_cselect_b32 s74, 4, 0
    s_or_b32 s73, s73, s74
L_gck_79:
    s_bitcmp1_b32 s73, 3
    s_cbranch_scc1 L_gck_80
    v_max3_u32 v80, v60, v61, v62
    v_max_u32 v80, v80, v63
    v_cmp_eq_u32 vcc, -1, v80
    s_nop 0
    s_cmp_eq_u64 vcc, 0
    s_cselect_b32 s74, 8, 0
    s_or_b32 s73, s73, s74
L_gck_80:
    s_bitcmp1_b32 s73, 4
    s_cbranch_scc1 L_gck_81
    v_max3_u32 v80, v64, v65, v66
    v_max_u32 v80, v80, v67
    v_cmp_eq_u32 vcc, -1, v80
    s_nop 0
    s_cmp_eq_u64 vcc, 0
    s_cselect_b32 s74, 16, 0
    s_or_b32 s73, s73, s74
L_gck_81:
    s_bitcmp1_b32 s73, 5
    s_cbranch_scc1 L_gck_82
    v_max3_u32 v80, v68, v69, v70
    v_max_u32 v80, v80, v71
    v_cmp_eq_u32 vcc, -1, v80
    s_nop 0
    s_cmp_eq_u64 vcc, 0
    s_cselect_b32 s74, 32, 0
    s_or_b32 s73, s73, s74
L_gck_82:
    s_bitcmp1_b32 s73, 6
    s_cbranch_scc1 L_gck_83
    v_max3_u32 v80, v72, v73, v74
    v_max_u32 v80, v80, v75
    v_cmp_eq_u32 vcc, -1, v80
    s_nop 0
    s_cmp_eq_u64 vcc, 0
    s_cselect_b32 s74, 64, 0
    s_or_b32 s73, s73, s74
L_gck_83:
    s_bitcmp1_b32 s73, 7
    s_cbranch_scc1 L_gck_84
    v_max3_u32 v80, v76, v77, v78
    v_max_u32 v80, v80, v79
    v_cmp_eq_u32 vcc, -1, v80
    s_nop 0
    s_cmp_eq_u64 vcc, 0
    s_cselect_b32 s74, 128, 0
    s_or_b32 s73, s73, s74
L_gck_84:
    s_bcnt1_i32_b32 s74, s73
    s_cmp_eq_u32 s74, 8
    s_cbranch_scc1 L_gsdone_67
    s_cmp_eq_u32 s74, 7
    s_cbranch_scc1 L_gslast_68
    s_cmp_lg_u32 s73, 0
    s_cbranch_scc1 L_gsns_85
    s_sleep 8
L_gsns_85:
    s_sub_u32 s72, s72, 1
    s_cmp_lg_u32 s72, 0
    s_cbranch_scc1 L_gs_66
    s_branch L_gsdone_67
L_gslast_68:
    s_ff0_i32_b32 s75, s73
    s_lshl_b32 s57, s75, 13
    s_add_u32 s57, s57, s52
    s_lshl_b32 s75, s75, 2
L_gsl_86:
    buffer_load_dwordx4 v[112:115], v5, s[40:43], s57 offen sc1
    s_waitcnt vmcnt(0)
    v_max3_u32 v80, v112, v113, v114
    v_max_u32 v80, v80, v115
    v_cmp_eq_u32 vcc, -1, v80
    s_nop 0
    s_cbranch_vccz L_gsgot_87
    s_sub_u32 s72, s72, 1
    s_cmp_lg_u32 s72, 0
    s_cbranch_scc1 L_gsl_86
L_gsgot_87:
    s_set_gpr_idx_on s75, gpr_idx(DST)
    s_nop 0
    v_mov_b32 v48, v112
    v_mov_b32 v49, v113
    v_mov_b32 v50, v114
    v_mov_b32 v51, v115
    s_set_gpr_idx_off
L_gsfin_88:
    s_nop 0
    v_pk_add_f32 v[80:81], v[48:49], v[52:53]
    v_pk_add_f32 v[82:83], v[50:51], v[54:55]
    v_pk_add_f32 v[84:85], v[56:57], v[60:61]
    v_pk_add_f32 v[86:87], v[58:59], v[62:63]
    v_pk_add_f32 v[88:89], v[64:65], v[68:69]
    v_pk_add_f32 v[90:91], v[66:67], v[70:71]
    v_pk_add_f32 v[92:93], v[72:73], v[76:77]
    v_pk_add_f32 v[94:95], v[74:75], v[78:79]
    v_pk_add_f32 v[80:81], v[80:81], v[84:85]
    v_pk_add_f32 v[82:83], v[82:83], v[86:87]
    v_pk_add_f32 v[88:89], v[88:89], v[92:93]
    v_pk_add_f32 v[90:91], v[90:91], v[94:95]
    v_pk_add_f32 v[16:17], v[80:81], v[88:89]
    v_pk_add_f32 v[18:19], v[82:83], v[90:91]
L_gsdone_67:
    v_pk_fma_f32 v[8:9], v[16:17], v[28:29], v[8:9]
    v_pk_fma_f32 v[10:11], v[18:19], v[30:31], v[10:11]
    v_cvt_pk_bf16_f32 v8, 0, v8
    v_cvt_pk_bf16_f32 v9, 0, v9
    v_cvt_pk_bf16_f32 v10, 0, v10
    v_cvt_pk_bf16_f32 v11, 0, v11
    v_pk_mul_f32 v[16:17], v[8:9], v[36:37]
    v_pk_mul_f32 v[18:19], v[10:11], v[38:39]
    v_cvt_pk_bf16_f32 v22, v16, v17
    v_cvt_pk_bf16_f32 v23, v18, v19
    ds_write_b64 v43, v[22:23]
    s_setprio 3
    v_mov_b32_dpp v12, v8 row_newbcast:0 row_mask:0xf bank_mask:0xf
    v_sub_f32 v16, v8, v12
    v_sub_f32 v17, v9, v12
    v_sub_f32 v18, v10, v12
    v_sub_f32 v19, v11, v12
    v_mul_f32 v13, v16, v16
    v_add_f32 v14, v16, v17
    v_fmac_f32 v13, v17, v17
    v_add_f32 v15, v18, v19
    v_fmac_f32 v13, v18, v18
    v_add_f32 v14, v14, v15
    v_fmac_f32 v13, v19, v19
    s_nop 0
    v_add_f32_dpp v14, v14, v14 row_ror:8 row_mask:0xf bank_mask:0xf
    v_add_f32_dpp v13, v13, v13 row_ror:8 row_mask:0xf bank_mask:0xf
    s_nop 0
    v_add_f32_dpp v14, v14, v14 row_ror:4 row_mask:0xf bank_mask:0xf
    v_add_f32_dpp v13, v13, v13 row_ror:4 row_mask:0xf bank_mask:0xf
    s_nop 0
    v_add_f32_dpp v14, v14, v14 row_ror:2 row_mask:0xf bank_mask:0xf
    v_add_f32_dpp v13, v13, v13 row_ror:2 row_mask:0xf bank_mask:0xf
    s_nop 0
    v_add_f32_dpp v14, v14, v14 row_ror:1 row_mask:0xf bank_mask:0xf
    v_add_f32_dpp v13, v13, v13 row_ror:1 row_mask:0xf bank_mask:0xf
    v_mul_f32 v15, 0x3c800000, v14
    v_add_f32 v12, v12, v15
    v_fma_f32 v13, -v15, v14, v13
    s_mov_b32 exec_lo, 0x10001
    s_mov_b32 exec_hi, 0x10001
    ds_write_b64 v41, v[12:13]
    s_mov_b64 exec, -1
    s_waitcnt lgkmcnt(0)
    s_barrier
    ds_read_b64 v[12:13], v42
    ds_write_b128 v40, v[8:11]
    s_cmp_lg_u32 s3, 0
    s_cbranch_scc1 L_nostat
    v_lshlrev_b32 v20, 2, v2
    v_add_u32 v20, 140640, v20
    s_waitcnt lgkmcnt(0)
    v_add_f32_dpp v14, v12, v12 row_ror:4 row_mask:0xf bank_mask:0xf
    s_nop 1
    v_add_f32_dpp v14, v14, v14 row_ror:2 row_mask:0xf bank_mask:0xf
    s_nop 1
    v_add_f32_dpp v14, v14, v14 row_ror:1 row_mask:0xf bank_mask:0xf
    v_mul_f32 v14, 0x3e000000, v14
    v_sub_f32 v12, v12, v14
    v_mul_f32 v12, v12, v12
    v_fmac_f32 v13, 0x42800000, v12
    v_cvt_pk_bf16_f32 v14, 0, v14
    s_nop 0
    v_add_f32_dpp v13, v13, v13 row_ror:4 row_mask:0xf bank_mask:0xf
    s_nop 1
    v_add_f32_dpp v13, v13, v13 row_ror:2 row_mask:0xf bank_mask:0xf
    s_nop 1
    v_add_f32_dpp v13, v13, v13 row_ror:1 row_mask:0xf bank_mask:0xf
    v_mul_f32 v13, 0x3b000000, v13
    v_cvt_pk_bf16_f32 v13, 0, v13
    v_add_f32 v13, 0x3727c5ac, v13
    v_cvt_pk_bf16_f32 v13, 0, v13
    v_sqrt_f32 v13, v13
    s_nop 0
    v_cvt_pk_bf16_f32 v13, 0, v13
    v_rcp_f32 v13, v13
    s_nop 0
    v_mul_f32 v14, -v14, v13
    s_mov_b32 exec_lo, 0x10001
    s_mov_b32 exec_hi, 0x10001
    ds_write2_b32 v20, v13, v14 offset0:0 offset1:4
    s_mov_b64 exec, -1
L_nostat:
    s_waitcnt lgkmcnt(0)
    s_barrier
    s_cmp_ge_u32 s3, 4
    s_cbranch_scc1 L_fin
    s_cmp_ge_u32 s64, 32
    s_cbranch_scc1 L_fin
    v_cmp_ne_u32 s[76:77], s63, v27
    s_nop 0
    s_cmp_eq_u64 s[76:77], 0
    s_cbranch_scc1 L_gbok
    s_mov_b32 s72, 1000000
L_pp_89:
    buffer_load_dwordx2 v[26:27], v46, s[40:43], s59 offen sc1
    s_waitcnt vmcnt(0)
    v_cmp_ne_u32 s[76:77], s63, v27
    s_nop 0
    s_cmp_eq_u64 s[76:77], 0
    s_cbranch_scc1 L_ppdone_91
    s_sleep 2
    s_sub_u32 s72, s72, 1
    s_cmp_lg_u32 s72, 0
    s_cbranch_scc1 L_pp_89
L_ppdone_91:
L_ppend_90:
L_gbok:
    v_lshlrev_b32 v47, 16, v26
    v_and_b32 v27, 0xffff0000, v26
    v_and_b32 v6, 1, v0
    v_cmp_eq_u32 vcc, 1, v6
    s_nop 1
    v_cndmask_b32 v47, v47, v27, vcc
    s_mov_b32 s44, s26
    s_mov_b32 s45, s27
    s_mov_b32 s46, 4096
    s_mov_b32 s47, 0x20000
    v_lshlrev_b32 v7, 4, v44
    v_lshlrev_b32 v10, 10, v45
    v_lshl_add_u32 v10, v44, 1, v10
    v_lshlrev_b32 v8, 1, v10
    v_add_u32 v8, 4096, v8
    ds_read_b32 v9, v8
    v_and_b32 v7, 0x183, v44
    v_lshlrev_b32 v7, 4, v7
    v_bfe_u32 v11, v44, 2, 1
    v_lshl_add_u32 v7, v11, 10, v7
    v_bfe_u32 v11, v44, 3, 4
    v_lshl_add_u32 v7, v11, 6, v7
    v_lshrrev_b32 v11, 2, v0
    v_lshl_add_u32 v7, v11, 13, v7
    v_mov_b32 v60, 0
    v_mov_b32 v61, 0
    v_mov_b32 v62, 0
    v_mov_b32 v63, 0
    s_mov_b32 s52, 851968
    s_mov_b32 s53, 983040
    s_mov_b32 s54, 1114112
    s_mov_b32 s55, 1245184
    s_waitcnt lgkmcnt(0)
    s_barrier
    s_mov_b32 s72, 1000000
L_gp_92:
    buffer_load_dwordx4 v[48:51], v7, s[40:43], s52 offen sc1
    buffer_load_dwordx4 v[52:55], v7, s[40:43], s53 offen sc1
    buffer_load_dwordx4 v[56:59], v7, s[40:43], s54 offen sc1
    s_mov_b32 exec_hi, 0
    buffer_load_dwordx4 v[60:63], v7, s[40:43], s55 offen sc1
    s_mov_b64 exec, -1
    s_waitcnt vmcnt(0)
    v_pk_add_f32 v[24:25], v[48:49], v[52:53]
    v_pk_add_f32 v[26:27], v[50:51], v[54:55]
    v_pk_add_f32 v[28:29], v[56:57], v[60:61]
    v_pk_add_f32 v[30:31], v[58:59], v[62:63]
    v_pk_add_f32 v[16:17], v[24:25], v[28:29]
    v_pk_add_f32 v[18:19], v[26:27], v[30:31]
    v_cmp_u_f32 s[76:77], v16, v17
    v_cmp_u_f32 vcc, v18, v19
    s_nop 0
    s_or_b64 vcc, vcc, s[76:77]
    s_cbranch_vccz L_gpdone_93
    v_max3_u32 v24, v48, v49, v50
    v_max3_u32 v24, v24, v51, v52
    v_max3_u32 v24, v24, v53, v54
    v_max3_u32 v24, v24, v55, v56
    v_max3_u32 v24, v24, v57, v58
    v_max3_u32 v24, v24, v59, v60
    v_max3_u32 v24, v24, v61, v62
    v_max_u32 v24, v24, v63
    v_cmp_eq_u32 vcc, -1, v24
    s_nop 0
    s_cbranch_vccz L_gpdone_93
    s_sub_u32 s72, s72, 1
    s_cmp_lg_u32 s72, 0
    s_cbranch_scc1 L_gp_92
L_gpdone_93:
    v_permlane32_swap_b32 v16, v17
    v_permlane32_swap_b32 v18, v19
    v_add_f32 v16, v16, v17
    v_add_f32 v18, v18, v19
    s_nop 1
    v_permlane16_swap_b32 v16, v18
    v_add_f32 v16, v16, v18
    s_nop 1
    v_add_f32_dpp v16, v16, v16 row_ror:8 row_mask:0xf bank_mask:0xf
    s_nop 1
    v_add_f32_dpp v16, v16, v16 row_ror:4 row_mask:0xf bank_mask:0xf
    v_cvt_pk_bf16_f32 v16, 0, v16
    v_mul_f32 v16, v16, v47
    v_cvt_pk_bf16_f32 v16, 0, v16
    v_add_f32 v16, v16, v9
    v_cvt_pk_bf16_f32 v16, v16, v16
    s_mov_b32 exec_lo, 0xf000f
    s_mov_b32 exec_hi, 0xf000f
    buffer_store_short v16, v10, s[44:47], 0 offen
    s_mov_b64 exec, -1
    s_or_b32 s74, s64, s3
    s_cmp_lg_u32 s74, 0
    s_cbranch_scc1 L_fin
    v_mov_b32 v5, 0
    v_mov_b32 v6, s63
    s_mov_b64 exec, 1
    buffer_store_dword v6, v5, s[40:43], 0 offen offset:0
    s_mov_b64 exec, -1
    s_branch L_fin
L_h_q:
    s_waitcnt lgkmcnt(0)
    s_load_dword s63, s[30:31], 0
    s_mov_b32 s40, s30
    s_mov_b32 s41, s31
    s_mov_b32 s42, 2097152
    s_mov_b32 s43, 0x20000
    s_mov_b32 s32, s10
    s_mov_b32 s33, s11
    s_mov_b32 s34, 4194304
    s_mov_b32 s35, 0x20000
    s_lshl_b32 s75, s64, 7
    s_mul_i32 s73, s69, 1048576
    s_add_u32 s73, s73, s75
    v_mul_u32_u24 v3, 65536, v2
    v_lshl_add_u32 v3, v1, 3, v3
    v_add_u32 v3, s73, v3
    s_mov_b32 s44, s4
    s_mov_b32 s45, s5
    s_mov_b32 s46, 4096
    s_mov_b32 s47, 0x20000
    v_lshlrev_b32 v8, 4, v0
    buffer_load_dwordx4 v[104:107], v8, s[44:47], 0 offen offset:0
    buffer_load_dwordx4 v[108:111], v8, s[44:47], 0 offen offset:1024
    buffer_load_dwordx4 v[112:115], v8, s[44:47], 0 offen offset:2048
    buffer_load_dwordx4 v[116:119], v8, s[44:47], 0 offen offset:3072
    v_lshrrev_b32 v10, 5, v0
    v_and_b32 v11, 31, v0
    s_lshl_b32 s74, s69, 5
    v_add_u32 v11, s74, v11
    v_lshlrev_b32 v8, 10, v10
    v_lshl_add_u32 v8, v11, 3, v8
    buffer_load_dwordx2 v[4:5], v8, s[44:47], 0 offen offset:0
    buffer_load_dwordx2 v[6:7], v8, s[44:47], 0 offen offset:2048
    s_mov_b64 vcc, 0
    s_mov_b32 s74, 0
    buffer_load_dwordx2 v[40:41], v3, s[32:35], s74 offen nt
    s_mov_b32 s74, 8192
    buffer_load_dwordx2 v[42:43], v3, s[32:35], s74 offen nt
    s_mov_b32 s74, 16384
    buffer_load_dwordx2 v[44:45], v3, s[32:35], s74 offen nt
    s_mov_b32 s74, 24576
    buffer_load_dwordx2 v[46:47], v3, s[32:35], s74 offen nt
    s_mov_b32 s74, 32768
    buffer_load_dwordx2 v[48:49], v3, s[32:35], s74 offen nt
    s_mov_b32 s74, 40960
    buffer_load_dwordx2 v[50:51], v3, s[32:35], s74 offen nt
    s_barrier
    s_mov_b32 s74, 49152
    buffer_load_dwordx2 v[52:53], v3, s[32:35], s74 offen nt
    s_mov_b32 s74, 57344
    buffer_load_dwordx2 v[54:55], v3, s[32:35], s74 offen nt
    s_mov_b32 s74, 262144
    buffer_load_dwordx2 v[56:57], v3, s[32:35], s74 offen nt
    s_mov_b32 s74, 270336
    buffer_load_dwordx2 v[58:59], v3, s[32:35], s74 offen nt
    s_mov_b32 s74, 278528
    buffer_load_dwordx2 v[60:61], v3, s[32:35], s74 offen nt
    s_mov_b32 s74, 286720
    buffer_load_dwordx2 v[62:63], v3, s[32:35], s74 offen nt
    s_mov_b32 s74, 294912
    buffer_load_dwordx2 v[64:65], v3, s[32:35], s74 offen nt
    s_mov_b32 s74, 303104
    buffer_load_dwordx2 v[66:67], v3, s[32:35], s74 offen nt
    s_mov_b32 s74, 311296
    buffer_load_dwordx2 v[68:69], v3, s[32:35], s74 offen nt
    s_mov_b32 s74, 319488
    buffer_load_dwordx2 v[70:71], v3, s[32:35], s74 offen nt
    s_mov_b32 s74, 524288
    buffer_load_dwordx2 v[72:73], v3, s[32:35], s74 offen nt
    s_mov_b32 s74, 532480
    buffer_load_dwordx2 v[74:75], v3, s[32:35], s74 offen nt
    s_mov_b32 s74, 540672
    buffer_load_dwordx2 v[76:77], v3, s[32:35], s74 offen nt
    s_mov_b32 s74, 548864
    buffer_load_dwordx2 v[78:79], v3, s[32:35], s74 offen nt
    s_mov_b32 s74, 557056
    buffer_load_dwordx2 v[80:81], v3, s[32:35], s74 offen nt
    s_mov_b32 s74, 565248
    buffer_load_dwordx2 v[82:83], v3, s[32:35], s74 offen nt
    s_mov_b32 s74, 573440
    buffer_load_dwordx2 v[84:85], v3, s[32:35], s74 offen nt
    s_mov_b32 s74, 581632
    buffer_load_dwordx2 v[86:87], v3, s[32:35], s74 offen nt
    s_mov_b32 s74, 786432
    buffer_load_dwordx2 v[88:89], v3, s[32:35], s74 offen nt
    s_mov_b32 s74, 794624
    buffer_load_dwordx2 v[90:91], v3, s[32:35], s74 offen nt
    s_mov_b32 s74, 802816
    buffer_load_dwordx2 v[92:93], v3, s[32:35], s74 offen nt
    s_mov_b32 s74, 811008
    buffer_load_dwordx2 v[94:95], v3, s[32:35], s74 offen nt
    s_mov_b32 s74, 819200
    buffer_load_dwordx2 v[96:97], v3, s[32:35], s74 offen nt
    s_mov_b32 s74, 827392
    buffer_load_dwordx2 v[98:99], v3, s[32:35], s74 offen nt
    s_mov_b32 s74, 835584
    buffer_load_dwordx2 v[100:101], v3, s[32:35], s74 offen nt
    s_waitcnt lgkmcnt(0)
    s_add_u32 s63, s63, 2654435769
    s_mov_b32 s74, 843776
    buffer_load_dwordx2 v[102:103], v3, s[32:35], s74 offen nt
    v_and_b32 v36, 3, v0
    v_mul_u32_u24 v36, 1088, v36
    v_lshl_add_u32 v36, v2, 4, v36
    s_lshl_b32 s74, s69, 8
    s_add_u32 s74, s74, 132096
    v_add_u32 v36, s74, v36
    v_lshlrev_b32 v38, 4, v0
    v_add_u32 v38, 136448, v38
    s_lshl_b32 s74, s69, 10
    v_add_u32 v37, s74, v38
    v_lshlrev_b32 v39, 6, v1
    v_lshl_add_u32 v39, v2, 4, v39
    v_lshlrev_b32 v34, 12, v10
    v_lshl_add_u32 v34, v11, 4, v34
    v_mul_u32_u24 v35, 1088, v10
    v_lshl_add_u32 v35, v11, 3, v35
    v_add_u32 v35, 132096, v35
    s_waitcnt vmcnt(32)
    v_lshlrev_b32 v120, 16, v104
    v_and_b32 v121, 0xffff0000, v104
    v_lshlrev_b32 v122, 16, v105
    v_and_b32 v123, 0xffff0000, v105
    v_lshlrev_b32 v124, 16, v106
    v_and_b32 v125, 0xffff0000, v106
    v_lshlrev_b32 v126, 16, v107
    v_and_b32 v127, 0xffff0000, v107
    v_lshlrev_b32 v128, 16, v108
    v_and_b32 v129, 0xffff0000, v108
    v_lshlrev_b32 v130, 16, v109
    v_and_b32 v131, 0xffff0000, v109
    v_lshlrev_b32 v132, 16, v110
    v_and_b32 v133, 0xffff0000, v110
    v_lshlrev_b32 v134, 16, v111
    v_and_b32 v135, 0xffff0000, v111
    v_lshlrev_b32 v136, 16, v112
    v_and_b32 v137, 0xffff0000, v112
    v_lshlrev_b32 v138, 16, v113
    v_and_b32 v139, 0xffff0000, v113
    v_lshlrev_b32 v140, 16, v114
    v_and_b32 v141, 0xffff0000, v114
    v_lshlrev_b32 v142, 16, v115
    v_and_b32 v143, 0xffff0000, v115
    v_lshlrev_b32 v144, 16, v116
    v_and_b32 v145, 0xffff0000, v116
    v_lshlrev_b32 v146, 16, v117
    v_and_b32 v147, 0xffff0000, v117
    v_lshlrev_b32 v148, 16, v118
    v_and_b32 v149, 0xffff0000, v118
    v_lshlrev_b32 v150, 16, v119
    v_and_b32 v151, 0xffff0000, v119
    v_add_f32 v12, v120, v121
    v_add_f32 v13, v128, v129
    v_add_f32 v14, v136, v137
    v_add_f32 v15, v144, v145
    v_add_f32 v12, v12, v122
    v_add_f32 v13, v13, v130
    v_add_f32 v14, v14, v138
    v_add_f32 v15, v15, v146
    v_add_f32 v12, v12, v123
    v_add_f32 v13, v13, v131
    v_add_f32 v14, v14, v139
    v_add_f32 v15, v15, v147
    v_add_f32 v12, v12, v124
    v_add_f32 v13, v13, v132
    v_add_f32 v14, v14, v140
    v_add_f32 v15, v15, v148
    v_add_f32 v12, v12, v125
    v_add_f32 v13, v13, v133
    v_add_f32 v14, v14, v141
    v_add_f32 v15, v15, v149
    v_add_f32 v12, v12, v126
    v_add_f32 v13, v13, v134
    v_add_f32 v14, v14, v142
    v_add_f32 v15, v15, v150
    v_add_f32 v12, v12, v127
    v_add_f32 v13, v13, v135
    v_add_f32 v14, v14, v143
    v_add_f32 v15, v15, v151
    v_permlane32_swap_b32 v12, v13
    s_nop 0
    v_permlane32_swap_b32 v14, v15
    v_add_f32 v12, v12, v13
    v_add_f32 v14, v14, v15
    s_nop 1
    v_permlane16_swap_b32 v12, v14
    v_add_f32 v12, v12, v14
    s_nop 1
    v_add_f32_dpp v12, v12, v12 row_ror:8 row_mask:0xf bank_mask:0xf
    s_nop 1
    v_add_f32_dpp v12, v12, v12 row_ror:4 row_mask:0xf bank_mask:0xf
    s_nop 1
    v_add_f32_dpp v12, v12, v12 row_ror:2 row_mask:0xf bank_mask:0xf
    s_nop 1
    v_add_f32_dpp v12, v12, v12 row_ror:1 row_mask:0xf bank_mask:0xf
    v_mul_f32 v12, 0x3b000000, v12
    s_nop 0
    v_readlane_b32 s52, v12, 0
    v_readlane_b32 s53, v12, 32
    v_readlane_b32 s54, v12, 16
    v_readlane_b32 s55, v12, 48
    v_subrev_f32 v120, s52, v120
    v_subrev_f32 v128, s53, v128
    v_subrev_f32 v136, s54, v136
    v_subrev_f32 v144, s55, v144
    v_subrev_f32 v121, s52, v121
    v_subrev_f32 v129, s53, v129
    v_subrev_f32 v137, s54, v137
    v_subrev_f32 v145, s55, v145
    v_subrev_f32 v122, s52, v122
    v_subrev_f32 v130, s53, v130
    v_subrev_f32 v138, s54, v138
    v_subrev_f32 v146, s55, v146
    v_subrev_f32 v123, s52, v123
    v_subrev_f32 v131, s53, v131
    v_subrev_f32 v139, s54, v139
    v_subrev_f32 v147, s55, v147
    v_subrev_f32 v124, s52, v124
    v_subrev_f32 v132, s53, v132
    v_subrev_f32 v140, s54, v140
    v_subrev_f32 v148, s55, v148
    v_subrev_f32 v125, s52, v125
    v_subrev_f32 v133, s53, v133
    v_subrev_f32 v141, s54, v141
    v_subrev_f32 v149, s55, v149
    v_subrev_f32 v126, s52, v126
    v_subrev_f32 v134, s53, v134
    v_subrev_f32 v142, s54, v142
    v_subrev_f32 v150, s55, v150
    v_subrev_f32 v127, s52, v127
    v_subrev_f32 v135, s53, v135
    v_subrev_f32 v143, s54, v143
    v_subrev_f32 v151, s55, v151
    v_mul_f32 v16, v120, v120
    v_mul_f32 v17, v128, v128
    v_mul_f32 v18, v136, v136
    v_mul_f32 v19, v144, v144
    v_fmac_f32 v16, v121, v121
    v_fmac_f32 v17, v129, v129
    v_fmac_f32 v18, v137, v137
    v_fmac_f32 v19, v145, v145
    v_fmac_f32 v16, v122, v122
    v_fmac_f32 v17, v130, v130
    v_fmac_f32 v18, v138, v138
    v_fmac_f32 v19, v146, v146
    v_fmac_f32 v16, v123, v123
    v_fmac_f32 v17, v131, v131
    v_fmac_f32 v18, v139, v139
    v_fmac_f32 v19, v147, v147
    v_fmac_f32 v16, v124, v124
    v_fmac_f32 v17, v132, v132
    v_fmac_f32 v18, v140, v140
    v_fmac_f32 v19, v148, v148
    v_fmac_f32 v16, v125, v125
    v_fmac_f32 v17, v133, v133
    v_fmac_f32 v18, v141, v141
    v_fmac_f32 v19, v149, v149
    v_fmac_f32 v16, v126, v126
    v_fmac_f32 v17, v134, v134
    v_fmac_f32 v18, v142, v142
    v_fmac_f32 v19, v150, v150
    v_fmac_f32 v16, v127, v127
    v_fmac_f32 v17, v135, v135
    v_fmac_f32 v18, v143, v143
    v_fmac_f32 v19, v151, v151
    v_permlane32_swap_b32 v16, v17
    s_nop 0
    v_permlane32_swap_b32 v18, v19
    v_add_f32 v16, v16, v17
    v_add_f32 v18, v18, v19
    s_nop 1
    v_permlane16_swap_b32 v16, v18
    v_add_f32 v16, v16, v18
    s_nop 1
    v_add_f32_dpp v16, v16, v16 row_ror:8 row_mask:0xf bank_mask:0xf
    s_nop 1
    v_add_f32_dpp v16, v16, v16 row_ror:4 row_mask:0xf bank_mask:0xf
    s_nop 1
    v_add_f32_dpp v16, v16, v16 row_ror:2 row_mask:0xf bank_mask:0xf
    s_nop 1
    v_add_f32_dpp v16, v16, v16 row_ror:1 row_mask:0xf bank_mask:0xf
    v_mul_f32 v16, 0x3b000000, v16
    v_cvt_pk_bf16_f32 v12, 0, v12
    v_cvt_pk_bf16_f32 v16, 0, v16
    v_add_f32 v16, 0x3727c5ac, v16
    v_cvt_pk_bf16_f32 v16, 0, v16
    v_sqrt_f32 v16, v16
    s_nop 0
    v_cvt_pk_bf16_f32 v16, 0, v16
    v_rcp_f32 v16, v16
    v_mov_b32 v20, v12
    v_mov_b32 v21, v12
    v_mov_b32 v17, v16
    s_nop 0
    v_permlane16_swap_b32 v20, v21
    v_permlane16_swap_b32 v16, v17
    v_lshlrev_b32 v8, 16, v4
    v_and_b32 v9, 0xffff0000, v4
    v_lshlrev_b32 v10, 16, v5
    v_and_b32 v11, 0xffff0000, v5
    v_lshlrev_b32 v12, 16, v6
    v_and_b32 v13, 0xffff0000, v6
    v_lshlrev_b32 v14, 16, v7
    v_and_b32 v15, 0xffff0000, v7
    v_sub_f32 v8, v8, v20
    v_sub_f32 v9, v9, v20
    v_sub_f32 v10, v10, v20
    v_sub_f32 v11, v11, v20
    v_sub_f32 v12, v12, v21
    v_sub_f32 v13, v13, v21
    v_sub_f32 v14, v14, v21
    v_sub_f32 v15, v15, v21
    v_cvt_pk_bf16_f32 v8, 0, v8
    v_cvt_pk_bf16_f32 v9, 0, v9
    v_cvt_pk_bf16_f32 v10, 0, v10
    v_cvt_pk_bf16_f32 v11, 0, v11
    v_cvt_pk_bf16_f32 v12, 0, v12
    v_cvt_pk_bf16_f32 v13, 0, v13
    v_cvt_pk_bf16_f32 v14, 0, v14
    v_cvt_pk_bf16_f32 v15, 0, v15
    v_mul_f32 v8, v8, v16
    v_mul_f32 v9, v9, v16
    v_mul_f32 v10, v10, v16
    v_mul_f32 v11, v11, v16
    v_mul_f32 v12, v12, v17
    v_mul_f32 v13, v13, v17
    v_mul_f32 v14, v14, v17
    v_mul_f32 v15, v15, v17
    v_cvt_pk_bf16_f32 v8, 0, v8
    v_cvt_pk_bf16_f32 v9, 0, v9
    v_cvt_pk_bf16_f32 v10, 0, v10
    v_cvt_pk_bf16_f32 v11, 0, v11
    v_cvt_pk_bf16_f32 v12, 0, v12
    v_cvt_pk_bf16_f32 v13, 0, v13
    v_cvt_pk_bf16_f32 v14, 0, v14
    v_cvt_pk_bf16_f32 v15, 0, v15
    s_mov_b32 s52, 4096
    s_mov_b32 s53, 12288
    s_waitcnt vmcnt(24)
    v_perm_b32 v104, v42, v40, s70
    v_perm_b32 v105, v46, v44, s70
    v_perm_b32 v106, v50, v48, s70
    v_perm_b32 v107, v54, v52, s70
    v_perm_b32 v108, v42, v40, s71
    v_perm_b32 v109, v46, v44, s71
    v_perm_b32 v110, v50, v48, s71
    v_perm_b32 v111, v54, v52, s71
    v_perm_b32 v112, v43, v41, s70
    v_perm_b32 v113, v47, v45, s70
    v_perm_b32 v114, v51, v49, s70
    v_perm_b32 v115, v55, v53, s70
    v_perm_b32 v116, v43, v41, s71
    v_perm_b32 v117, v47, v45, s71
    v_perm_b32 v118, v51, v49, s71
    v_perm_b32 v119, v55, v53, s71
    s_waitcnt vmcnt(16)
    v_perm_b32 v120, v58, v56, s70
    v_perm_b32 v121, v62, v60, s70
    v_perm_b32 v122, v66, v64, s70
    v_perm_b32 v123, v70, v68, s70
    v_perm_b32 v124, v58, v56, s71
    v_perm_b32 v125, v62, v60, s71
    v_perm_b32 v126, v66, v64, s71
    v_perm_b32 v127, v70, v68, s71
    v_perm_b32 v128, v59, v57, s70
    v_perm_b32 v129, v63, v61, s70
    v_perm_b32 v130, v67, v65, s70
    v_perm_b32 v131, v71, v69, s70
    v_perm_b32 v132, v59, v57, s71
    v_perm_b32 v133, v63, v61, s71
    v_perm_b32 v134, v67, v65, s71
    v_perm_b32 v135, v71, v69, s71
    s_waitcnt vmcnt(8)
    v_perm_b32 v136, v74, v72, s70
    v_perm_b32 v137, v78, v76, s70
    v_perm_b32 v138, v82, v80, s70
    v_perm_b32 v139, v86, v84, s70
    v_perm_b32 v140, v74, v72, s71
    v_perm_b32 v141, v78, v76, s71
    v_perm_b32 v142, v82, v80, s71
    v_perm_b32 v143, v86, v84, s71
    v_perm_b32 v144, v75, v73, s70
    v_perm_b32 v145, v79, v77, s70
    v_perm_b32 v146, v83, v81, s70
    v_perm_b32 v147, v87, v85, s70
    v_perm_b32 v148, v75, v73, s71
    v_perm_b32 v149, v79, v77, s71
    v_perm_b32 v150, v83, v81, s71
    v_perm_b32 v151, v87, v85, s71
    s_waitcnt vmcnt(0)
    v_perm_b32 v152, v90, v88, s70
    v_perm_b32 v153, v94, v92, s70
    v_perm_b32 v154, v98, v96, s70
    v_perm_b32 v155, v102, v100, s70
    v_perm_b32 v156, v90, v88, s71
    v_perm_b32 v157, v94, v92, s71
    v_perm_b32 v158, v98, v96, s71
    v_perm_b32 v159, v102, v100, s71
    v_perm_b32 v160, v91, v89, s70
    v_perm_b32 v161, v95, v93, s70
    v_perm_b32 v162, v99, v97, s70
    v_perm_b32 v163, v103, v101, s70
    v_perm_b32 v164, v91, v89, s71
    v_perm_b32 v165, v95, v93, s71
    v_perm_b32 v166, v99, v97, s71
    v_perm_b32 v167, v103, v101, s71
    v_mov_b32 v32, 140600
    s_mov_b32 s72, 64000000
L_lw_94:
    ds_read_b32 v33, v32
    s_waitcnt lgkmcnt(0)
    v_cmp_ne_u32 vcc, 1, v33
    s_nop 0
    s_cbranch_vccz L_lwdone_95
    s_sleep 2
    s_sub_u32 s72, s72, 1
    s_cmp_lg_u32 s72, 0
    s_cbranch_scc1 L_lw_94
L_lwdone_95:
    s_mov_b32 s72, 1000000
L_pp_96:
    buffer_load_dwordx4 v[40:43], v34, s[40:43], s52 offen offset:0 sc1
    buffer_load_dwordx4 v[44:47], v34, s[40:43], s53 offen offset:0 sc1
    buffer_load_dwordx4 v[48:51], v34, s[40:43], s52 offen offset:2048 sc1
    buffer_load_dwordx4 v[52:55], v34, s[40:43], s53 offen offset:2048 sc1
    s_waitcnt vmcnt(0)
    v_cmp_ne_u32 s[76:77], s63, v41
    v_cmp_ne_u32 vcc, s63, v43
    s_nop 0
    s_or_b64 s[76:77], s[76:77], vcc
    v_cmp_ne_u32 vcc, s63, v45
    s_nop 0
    s_or_b64 s[76:77], s[76:77], vcc
    v_cmp_ne_u32 vcc, s63, v47
    s_nop 0
    s_or_b64 s[76:77], s[76:77], vcc
    v_cmp_ne_u32 vcc, s63, v49
    s_nop 0
    s_or_b64 s[76:77], s[76:77], vcc
    v_cmp_ne_u32 vcc, s63, v51
    s_nop 0
    s_or_b64 s[76:77], s[76:77], vcc
    v_cmp_ne_u32 vcc, s63, v53
    s_nop 0
    s_or_b64 s[76:77], s[76:77], vcc
    v_cmp_ne_u32 vcc, s63, v55
    s_nop 0
    s_or_b64 s[76:77], s[76:77], vcc
    s_cmp_eq_u64 s[76:77], 0
    s_cbranch_scc1 L_ppdone_98
    s_sleep 2
    s_sub_u32 s72, s72, 1
    s_cmp_lg_u32 s72, 0
    s_cbranch_scc1 L_pp_96
L_ppdone_98:
    v_lshlrev_b32 v16, 16, v40
    v_and_b32 v17, 0xffff0000, v40
    v_lshlrev_b32 v18, 16, v42
    v_and_b32 v19, 0xffff0000, v42
    v_lshlrev_b32 v20, 16, v44
    v_and_b32 v21, 0xffff0000, v44
    v_lshlrev_b32 v22, 16, v46
    v_and_b32 v23, 0xffff0000, v46
    v_lshlrev_b32 v24, 16, v48
    v_and_b32 v25, 0xffff0000, v48
    v_lshlrev_b32 v26, 16, v50
    v_and_b32 v27, 0xffff0000, v50
    v_lshlrev_b32 v28, 16, v52
    v_and_b32 v29, 0xffff0000, v52
    v_lshlrev_b32 v30, 16, v54
    v_and_b32 v31, 0xffff0000, v54
L_ppend_97:
    v_add_f32 v24, 1.0, v24
    v_add_f32 v25, 1.0, v25
    v_add_f32 v26, 1.0, v26
    v_add_f32 v27, 1.0, v27
    v_add_f32 v28, 1.0, v28
    v_add_f32 v29, 1.0, v29
    v_add_f32 v30, 1.0, v30
    v_add_f32 v31, 1.0, v31
    v_cvt_pk_bf16_f32 v24, 0, v24
    v_cvt_pk_bf16_f32 v25, 0, v25
    v_cvt_pk_bf16_f32 v26, 0, v26
    v_cvt_pk_bf16_f32 v27, 0, v27
    v_cvt_pk_bf16_f32 v28, 0, v28
    v_cvt_pk_bf16_f32 v29, 0, v29
    v_cvt_pk_bf16_f32 v30, 0, v30
    v_cvt_pk_bf16_f32 v31, 0, v31
    v_pk_mul_f32 v[8:9], v[8:9], v[24:25]
    v_pk_mul_f32 v[10:11], v[10:11], v[26:27]
    v_pk_mul_f32 v[12:13], v[12:13], v[28:29]
    v_pk_mul_f32 v[14:15], v[14:15], v[30:31]
    v_cvt_pk_bf16_f32 v8, 0, v8
    v_cvt_pk_bf16_f32 v9, 0, v9
    v_cvt_pk_bf16_f32 v10, 0, v10
    v_cvt_pk_bf16_f32 v11, 0, v11
    v_cvt_pk_bf16_f32 v12, 0, v12
    v_cvt_pk_bf16_f32 v13, 0, v13
    v_cvt_pk_bf16_f32 v14, 0, v14
    v_cvt_pk_bf16_f32 v15, 0, v15
    v_pk_add_f32 v[8:9], v[8:9], v[16:17]
    v_pk_add_f32 v[10:11], v[10:11], v[18:19]
    v_pk_add_f32 v[12:13], v[12:13], v[20:21]
    v_pk_add_f32 v[14:15], v[14:15], v[22:23]
    v_cvt_pk_bf16_f32 v4, v8, v9
    v_cvt_pk_bf16_f32 v5, v10, v11
    v_cvt_pk_bf16_f32 v6, v12, v13
    v_cvt_pk_bf16_f32 v7, v14, v15
    ds_write_b64 v35, v[4:5]
    ds_write_b64 v35, v[6:7] offset:2176
    ds_read_b128 v[20:23], v36 offset:0
    ds_read_b128 v[24:27], v36 offset:64
    ds_read_b128 v[28:31], v36 offset:128
    ds_read_b128 v[32:35], v36 offset:192
    s_waitcnt lgkmcnt(3)
    v_mfma_f32_16x16x32_bf16 v[4:7], v[20:23], v[104:107], 0
    v_mfma_f32_16x16x32_bf16 v[8:11], v[20:23], v[108:111], 0
    v_mfma_f32_16x16x32_bf16 v[12:15], v[20:23], v[112:115], 0
    v_mfma_f32_16x16x32_bf16 v[16:19], v[20:23], v[116:119], 0
    s_waitcnt lgkmcnt(2)
    v_mfma_f32_16x16x32_bf16 v[4:7], v[24:27], v[120:123], v[4:7]
    v_mfma_f32_16x16x32_bf16 v[8:11], v[24:27], v[124:127], v[8:11]
    v_mfma_f32_16x16x32_bf16 v[12:15], v[24:27], v[128:131], v[12:15]
    v_mfma_f32_16x16x32_bf16 v[16:19], v[24:27], v[132:135], v[16:19]
    s_waitcnt lgkmcnt(1)
    v_mfma_f32_16x16x32_bf16 v[4:7], v[28:31], v[136:139], v[4:7]
    v_mfma_f32_16x16x32_bf16 v[8:11], v[28:31], v[140:143], v[8:11]
    v_mfma_f32_16x16x32_bf16 v[12:15], v[28:31], v[144:147], v[12:15]
    v_mfma_f32_16x16x32_bf16 v[16:19], v[28:31], v[148:151], v[16:19]
    s_waitcnt lgkmcnt(0)
    v_mfma_f32_16x16x32_bf16 v[4:7], v[32:35], v[152:155], v[4:7]
    v_mfma_f32_16x16x32_bf16 v[8:11], v[32:35], v[156:159], v[8:11]
    v_mfma_f32_16x16x32_bf16 v[12:15], v[32:35], v[160:163], v[12:15]
    v_mfma_f32_16x16x32_bf16 v[16:19], v[32:35], v[164:167], v[16:19]
    s_mov_b32 exec_lo, 0xffff
    s_mov_b32 exec_hi, 0x0
    s_nop 2
    ds_write_b128 v37, v[4:7] offset:0
    ds_write_b128 v37, v[8:11] offset:256
    ds_write_b128 v37, v[12:15] offset:512
    ds_write_b128 v37, v[16:19] offset:768
    s_mov_b64 exec, -1
    s_lshl_b32 s74, s69, 2
    s_add_u32 s74, s74, 140544
    v_mov_b32 v20, s74
    v_mov_b32 v21, 1
    s_mov_b64 exec, 1
    ds_write_b32 v20, v21
    s_mov_b64 exec, -1
    s_cmp_lg_u32 s69, 0
    s_cbranch_scc1 L_nopub_99
    s_lshl_b32 s75, s64, 8
    v_lshlrev_b32 v38, 4, v1
    v_lshl_add_u32 v39, v2, 14, v38
    v_lshl_add_u32 v38, v2, 2, v38
    v_add_u32 v38, 136448, v38
    s_add_u32 s75, s75, 65536
    v_mov_b32 v24, 140544
    s_mov_b32 s72, 64000000
L_lw_100:
    ds_read_b128 v[20:23], v24
    s_waitcnt lgkmcnt(0)
    v_and_b32 v20, v20, v22
    v_and_b32 v21, v21, v23
    v_and_b32 v20, v20, v21
    v_cmp_ne_u32 vcc, 1, v20
    s_nop 0
    s_cbranch_vccz L_lwdone_101
    s_sub_u32 s72, s72, 1
    s_cmp_lg_u32 s72, 0
    s_cbranch_scc1 L_lw_100
L_lwdone_101:
    ds_read_b32 v4, v38 offset:0
    ds_read_b32 v5, v38 offset:256
    ds_read_b32 v6, v38 offset:512
    ds_read_b32 v7, v38 offset:768
    ds_read_b32 v8, v38 offset:1024
    ds_read_b32 v9, v38 offset:1280
    ds_read_b32 v10, v38 offset:1536
    ds_read_b32 v11, v38 offset:1792
    ds_read_b32 v12, v38 offset:2048
    ds_read_b32 v13, v38 offset:2304
    ds_read_b32 v14, v38 offset:2560
    ds_read_b32 v15, v38 offset:2816
    ds_read_b32 v16, v38 offset:3072
    ds_read_b32 v17, v38 offset:3328
    ds_read_b32 v18, v38 offset:3584
    ds_read_b32 v19, v38 offset:3840
    s_waitcnt lgkmcnt(8)
    v_pk_add_f32 v[4:5], v[4:5], v[8:9]
    v_pk_add_f32 v[6:7], v[6:7], v[10:11]
    s_waitcnt lgkmcnt(0)
    v_pk_add_f32 v[12:13], v[12:13], v[16:17]
    v_pk_add_f32 v[14:15], v[14:15], v[18:19]
    v_pk_add_f32 v[4:5], v[4:5], v[12:13]
    v_pk_add_f32 v[6:7], v[6:7], v[14:15]
    v_cvt_pk_bf16_f32 v8, v4, v5
    v_mov_b32 v9, s63
    v_cvt_pk_bf16_f32 v10, v6, v7
    v_mov_b32 v11, s63
    buffer_store_dwordx4 v[8:11], v39, s[40:43], s75 offen sc1
L_nopub_99:
    s_branch L_h_common
L_h_modc:
    s_waitcnt lgkmcnt(0)
    s_load_dword s63, s[30:31], 0
    s_mov_b32 s40, s30
    s_mov_b32 s41, s31
    s_mov_b32 s42, 2097152
    s_mov_b32 s43, 0x20000
    v_mov_b32 v12, -1
    v_mov_b32 v13, -1
    v_mov_b32 v14, -1
    v_mov_b32 v15, -1
    s_lshl_b32 s74, s69, 10
    v_lshl_add_u32 v9, v0, 4, s74
    s_mov_b32 s44, s22
    s_mov_b32 s45, s23
    s_mov_b32 s46, 4096
    s_mov_b32 s47, 0x20000
    s_mov_b32 s32, s24
    s_mov_b32 s33, s25
    s_mov_b32 s34, 3145728
    s_mov_b32 s35, 0x20000
    s_lshl_b32 s74, s69, 8
    v_lshl_add_u32 v8, v0, 2, s74
    buffer_load_dword v4, v8, s[44:47], 0 offen offset:0
    buffer_load_dword v5, v8, s[44:47], 0 offen offset:1024
    buffer_load_dword v6, v8, s[44:47], 0 offen offset:2048
    buffer_load_dword v7, v8, s[44:47], 0 offen offset:3072
    s_lshl_b32 s75, s64, 7
    s_mul_i32 s73, s69, 786432
    s_add_u32 s73, s73, s75
    v_mul_u32_u24 v3, 49152, v2
    v_lshl_add_u32 v3, v1, 3, v3
    v_add_u32 v3, s73, v3
    s_lshl_b32 s73, s64, 12
    s_add_u32 s73, s73, 786432
    buffer_store_dwordx4 v[12:15], v9, s[40:43], s73 offen sc1
    s_mov_b32 s74, 0
    buffer_load_dwordx2 v[40:41], v3, s[32:35], s74 offen nt
    s_mov_b32 s74, 6144
    buffer_load_dwordx2 v[42:43], v3, s[32:35], s74 offen nt
    s_mov_b32 s74, 12288
    buffer_load_dwordx2 v[44:45], v3, s[32:35], s74 offen nt
    s_mov_b32 s74, 18432
    buffer_load_dwordx2 v[46:47], v3, s[32:35], s74 offen nt
    s_mov_b32 s74, 24576
    buffer_load_dwordx2 v[48:49], v3, s[32:35], s74 offen nt
    s_mov_b32 s74, 30720
    buffer_load_dwordx2 v[50:51], v3, s[32:35], s74 offen nt
    s_barrier
    s_mov_b32 s74, 36864
    buffer_load_dwordx2 v[52:53], v3, s[32:35], s74 offen nt
    s_mov_b32 s74, 43008
    buffer_load_dwordx2 v[54:55], v3, s[32:35], s74 offen nt
    s_mov_b32 s74, 196608
    buffer_load_dwordx2 v[56:57], v3, s[32:35], s74 offen nt
    s_mov_b32 s74, 202752
    buffer_load_dwordx2 v[58:59], v3, s[32:35], s74 offen nt
    s_mov_b32 s74, 208896
    buffer_load_dwordx2 v[60:61], v3, s[32:35], s74 offen nt
    s_mov_b32 s74, 215040
    buffer_load_dwordx2 v[62:63], v3, s[32:35], s74 offen nt
    s_mov_b32 s74, 221184
    buffer_load_dwordx2 v[64:65], v3, s[32:35], s74 offen nt
    s_mov_b32 s74, 227328
    buffer_load_dwordx2 v[66:67], v3, s[32:35], s74 offen nt
    s_mov_b32 s74, 233472
    buffer_load_dwordx2 v[68:69], v3, s[32:35], s74 offen nt
    s_mov_b32 s74, 239616
    buffer_load_dwordx2 v[70:71], v3, s[32:35], s74 offen nt
    s_mov_b32 s74, 393216
    buffer_load_dwordx2 v[72:73], v3, s[32:35], s74 offen nt
    s_mov_b32 s74, 399360
    buffer_load_dwordx2 v[74:75], v3, s[32:35], s74 offen nt
    s_mov_b32 s74, 405504
    buffer_load_dwordx2 v[76:77], v3, s[32:35], s74 offen nt
    s_mov_b32 s74, 411648
    buffer_load_dwordx2 v[78:79], v3, s[32:35], s74 offen nt
    s_mov_b32 s74, 417792
    buffer_load_dwordx2 v[80:81], v3, s[32:35], s74 offen nt
    s_mov_b32 s74, 423936
    buffer_load_dwordx2 v[82:83], v3, s[32:35], s74 offen nt
    s_mov_b32 s74, 430080
    buffer_load_dwordx2 v[84:85], v3, s[32:35], s74 offen nt
    s_mov_b32 s74, 436224
    buffer_load_dwordx2 v[86:87], v3, s[32:35], s74 offen nt
    s_mov_b32 s74, 589824
    buffer_load_dwordx2 v[88:89], v3, s[32:35], s74 offen nt
    s_mov_b32 s74, 595968
    buffer_load_dwordx2 v[90:91], v3, s[32:35], s74 offen nt
    s_mov_b32 s74, 602112
    buffer_load_dwordx2 v[92:93], v3, s[32:35], s74 offen nt
    s_mov_b32 s74, 608256
    buffer_load_dwordx2 v[94:95], v3, s[32:35], s74 offen nt
    s_mov_b32 s74, 614400
    buffer_load_dwordx2 v[96:97], v3, s[32:35], s74 offen nt
    s_mov_b32 s74, 620544
    buffer_load_dwordx2 v[98:99], v3, s[32:35], s74 offen nt
    s_mov_b32 s74, 626688
    buffer_load_dwordx2 v[100:101], v3, s[32:35], s74 offen nt
    s_waitcnt lgkmcnt(0)
    s_add_u32 s63, s63, 2654435769
    s_mov_b32 s74, 632832
    buffer_load_dwordx2 v[102:103], v3, s[32:35], s74 offen nt
    v_and_b32 v36, 3, v0
    v_mul_u32_u24 v36, 1088, v36
    v_lshl_add_u32 v36, v2, 4, v36
    s_lshl_b32 s74, s69, 8
    s_add_u32 s74, s74, 132096
    v_add_u32 v36, s74, v36
    v_lshlrev_b32 v38, 4, v0
    v_add_u32 v38, 136448, v38
    s_lshl_b32 s74, s69, 10
    v_add_u32 v37, s74, v38
    v_lshlrev_b32 v39, 6, v1
    v_lshl_add_u32 v39, v2, 4, v39
    s_waitcnt vmcnt(33)
    v_lshlrev_b32 v8, 16, v4
    v_and_b32 v9, 0xffff0000, v4
    v_lshlrev_b32 v10, 16, v5
    v_and_b32 v11, 0xffff0000, v5
    v_lshlrev_b32 v12, 16, v6
    v_and_b32 v13, 0xffff0000, v6
    v_lshlrev_b32 v14, 16, v7
    v_and_b32 v15, 0xffff0000, v7
    v_mul_f32 v16, 0xbfb8aa3b, v8
    v_mul_f32 v17, 0xbfb8aa3b, v9
    v_mul_f32 v18, 0xbfb8aa3b, v10
    v_mul_f32 v19, 0xbfb8aa3b, v11
    v_mul_f32 v20, 0xbfb8aa3b, v12
    v_mul_f32 v21, 0xbfb8aa3b, v13
    v_mul_f32 v22, 0xbfb8aa3b, v14
    v_mul_f32 v23, 0xbfb8aa3b, v15
    v_exp_f32 v16, v16
    v_exp_f32 v17, v17
    v_exp_f32 v18, v18
    v_exp_f32 v19, v19
    v_exp_f32 v20, v20
    v_exp_f32 v21, v21
    v_exp_f32 v22, v22
    v_exp_f32 v23, v23
    v_add_f32 v16, 1.0, v16
    v_add_f32 v17, 1.0, v17
    v_add_f32 v18, 1.0, v18
    v_add_f32 v19, 1.0, v19
    v_add_f32 v20, 1.0, v20
    v_add_f32 v21, 1.0, v21
    v_add_f32 v22, 1.0, v22
    v_add_f32 v23, 1.0, v23
    v_rcp_f32 v24, v16
    v_rcp_f32 v25, v17
    v_rcp_f32 v26, v18
    v_rcp_f32 v27, v19
    v_rcp_f32 v28, v20
    v_rcp_f32 v29, v21
    v_rcp_f32 v30, v22
    v_rcp_f32 v31, v23
    v_mul_f32 v152, v8, v24
    v_mul_f32 v153, v9, v25
    v_mul_f32 v154, v10, v26
    v_mul_f32 v155, v11, v27
    v_mul_f32 v156, v12, v28
    v_mul_f32 v157, v13, v29
    v_mul_f32 v158, v14, v30
    v_mul_f32 v159, v15, v31
    v_fma_f32 v160, -v152, v16, v8
    v_fma_f32 v161, -v153, v17, v9
    v_fma_f32 v162, -v154, v18, v10
    v_fma_f32 v163, -v155, v19, v11
    v_fma_f32 v164, -v156, v20, v12
    v_fma_f32 v165, -v157, v21, v13
    v_fma_f32 v166, -v158, v22, v14
    v_fma_f32 v167, -v159, v23, v15
    v_fma_f32 v152, v160, v24, v152
    v_fma_f32 v153, v161, v25, v153
    v_fma_f32 v154, v162, v26, v154
    v_fma_f32 v155, v163, v27, v155
    v_fma_f32 v156, v164, v28, v156
    v_fma_f32 v157, v165, v29, v157
    v_fma_f32 v158, v166, v30, v158
    v_fma_f32 v159, v167, v31, v159
    v_div_fixup_f32 v8, v152, v16, v8
    v_div_fixup_f32 v9, v153, v17, v9
    v_div_fixup_f32 v10, v154, v18, v10
    v_div_fixup_f32 v11, v155, v19, v11
    v_div_fixup_f32 v12, v156, v20, v12
    v_div_fixup_f32 v13, v157, v21, v13
    v_div_fixup_f32 v14, v158, v22, v14
    v_div_fixup_f32 v15, v159, v23, v15
    v_cvt_pk_bf16_f32 v4, v8, v9
    v_cvt_pk_bf16_f32 v5, v10, v11
    v_cvt_pk_bf16_f32 v6, v12, v13
    v_cvt_pk_bf16_f32 v7, v14, v15
    s_lshl_b32 s74, s69, 8
    s_add_u32 s74, s74, 132096
    v_lshl_add_u32 v35, v0, 2, s74
    ds_write_b32 v35, v4 offset:0
    ds_write_b32 v35, v5 offset:1088
    ds_write_b32 v35, v6 offset:2176
    ds_write_b32 v35, v7 offset:3264
    s_waitcnt vmcnt(24)
    v_perm_b32 v104, v42, v40, s70
    v_perm_b32 v105, v46, v44, s70
    v_perm_b32 v106, v50, v48, s70
    v_perm_b32 v107, v54, v52, s70
    v_perm_b32 v108, v42, v40, s71
    v_perm_b32 v109, v46, v44, s71
    v_perm_b32 v110, v50, v48, s71
    v_perm_b32 v111, v54, v52, s71
    v_perm_b32 v112, v43, v41, s70
    v_perm_b32 v113, v47, v45, s70
    v_perm_b32 v114, v51, v49, s70
    v_perm_b32 v115, v55, v53, s70
    v_perm_b32 v116, v43, v41, s71
    v_perm_b32 v117, v47, v45, s71
    v_perm_b32 v118, v51, v49, s71
    v_perm_b32 v119, v55, v53, s71
    s_waitcnt vmcnt(16)
    v_perm_b32 v120, v58, v56, s70
    v_perm_b32 v121, v62, v60, s70
    v_perm_b32 v122, v66, v64, s70
    v_perm_b32 v123, v70, v68, s70
    v_perm_b32 v124, v58, v56, s71
    v_perm_b32 v125, v62, v60, s71
    v_perm_b32 v126, v66, v64, s71
    v_perm_b32 v127, v70, v68, s71
    v_perm_b32 v128, v59, v57, s70
    v_perm_b32 v129, v63, v61, s70
    v_perm_b32 v130, v67, v65, s70
    v_perm_b32 v131, v71, v69, s70
    v_perm_b32 v132, v59, v57, s71
    v_perm_b32 v133, v63, v61, s71
    v_perm_b32 v134, v67, v65, s71
    v_perm_b32 v135, v71, v69, s71
    s_waitcnt vmcnt(8)
    v_perm_b32 v136, v74, v72, s70
    v_perm_b32 v137, v78, v76, s70
    v_perm_b32 v138, v82, v80, s70
    v_perm_b32 v139, v86, v84, s70
    v_perm_b32 v140, v74, v72, s71
    v_perm_b32 v141, v78, v76, s71
    v_perm_b32 v142, v82, v80, s71
    v_perm_b32 v143, v86, v84, s71
    v_perm_b32 v144, v75, v73, s70
    v_perm_b32 v145, v79, v77, s70
    v_perm_b32 v146, v83, v81, s70
    v_perm_b32 v147, v87, v85, s70
    v_perm_b32 v148, v75, v73, s71
    v_perm_b32 v149, v79, v77, s71
    v_perm_b32 v150, v83, v81, s71
    v_perm_b32 v151, v87, v85, s71
    s_waitcnt vmcnt(0)
    v_perm_b32 v152, v90, v88, s70
    v_perm_b32 v153, v94, v92, s70
    v_perm_b32 v154, v98, v96, s70
    v_perm_b32 v155, v102, v100, s70
    v_perm_b32 v156, v90, v88, s71
    v_perm_b32 v157, v94, v92, s71
    v_perm_b32 v158, v98, v96, s71
    v_perm_b32 v159, v102, v100, s71
    v_perm_b32 v160, v91, v89, s70
    v_perm_b32 v161, v95, v93, s70
    v_perm_b32 v162, v99, v97, s70
    v_perm_b32 v163, v103, v101, s70
    v_perm_b32 v164, v91, v89, s71
    v_perm_b32 v165, v95, v93, s71
    v_perm_b32 v166, v99, v97, s71
    v_perm_b32 v167, v103, v101, s71
    ds_read_b128 v[20:23], v36 offset:0
    ds_read_b128 v[24:27], v36 offset:64
    ds_read_b128 v[28:31], v36 offset:128
    ds_read_b128 v[32:35], v36 offset:192
    s_waitcnt lgkmcnt(3)
    v_mfma_f32_16x16x32_bf16 v[4:7], v[20:23], v[104:107], 0
    v_mfma_f32_16x16x32_bf16 v[8:11], v[20:23], v[108:111], 0
    v_mfma_f32_16x16x32_bf16 v[12:15], v[20:23], v[112:115], 0
    v_mfma_f32_16x16x32_bf16 v[16:19], v[20:23], v[116:119], 0
    s_waitcnt lgkmcnt(2)
    v_mfma_f32_16x16x32_bf16 v[4:7], v[24:27], v[120:123], v[4:7]
    v_mfma_f32_16x16x32_bf16 v[8:11], v[24:27], v[124:127], v[8:11]
    v_mfma_f32_16x16x32_bf16 v[12:15], v[24:27], v[128:131], v[12:15]
    v_mfma_f32_16x16x32_bf16 v[16:19], v[24:27], v[132:135], v[16:19]
    s_waitcnt lgkmcnt(1)
    v_mfma_f32_16x16x32_bf16 v[4:7], v[28:31], v[136:139], v[4:7]
    v_mfma_f32_16x16x32_bf16 v[8:11], v[28:31], v[140:143], v[8:11]
    v_mfma_f32_16x16x32_bf16 v[12:15], v[28:31], v[144:147], v[12:15]
    v_mfma_f32_16x16x32_bf16 v[16:19], v[28:31], v[148:151], v[16:19]
    s_waitcnt lgkmcnt(0)
    v_mfma_f32_16x16x32_bf16 v[4:7], v[32:35], v[152:155], v[4:7]
    v_mfma_f32_16x16x32_bf16 v[8:11], v[32:35], v[156:159], v[8:11]
    v_mfma_f32_16x16x32_bf16 v[12:15], v[32:35], v[160:163], v[12:15]
    v_mfma_f32_16x16x32_bf16 v[16:19], v[32:35], v[164:167], v[16:19]
    s_mov_b32 exec_lo, 0xffff
    s_mov_b32 exec_hi, 0x0
    s_nop 2
    ds_write_b128 v37, v[4:7] offset:0
    ds_write_b128 v37, v[8:11] offset:256
    ds_write_b128 v37, v[12:15] offset:512
    ds_write_b128 v37, v[16:19] offset:768
    s_mov_b64 exec, -1
    s_lshl_b32 s74, s69, 2
    s_add_u32 s74, s74, 140544
    v_mov_b32 v20, s74
    v_mov_b32 v21, 1
    s_mov_b64 exec, 1
    ds_write_b32 v20, v21
    s_mov_b64 exec, -1
    s_cmp_lg_u32 s69, 0
    s_cbranch_scc1 L_nopub_102
    s_lshl_b32 s75, s64, 8
    v_lshlrev_b32 v38, 4, v1
    v_lshl_add_u32 v39, v2, 12, v38
    v_lshl_add_u32 v38, v2, 2, v38
    v_add_u32 v38, 136448, v38
    s_add_u32 s75, s75, 4096
    v_mov_b32 v24, 140544
    s_mov_b32 s72, 64000000
L_lw_103:
    ds_read_b128 v[20:23], v24
    s_waitcnt lgkmcnt(0)
    v_and_b32 v20, v20, v22
    v_and_b32 v21, v21, v23
    v_and_b32 v20, v20, v21
    v_cmp_ne_u32 vcc, 1, v20
    s_nop 0
    s_cbranch_vccz L_lwdone_104
    s_sub_u32 s72, s72, 1
    s_cmp_lg_u32 s72, 0
    s_cbranch_scc1 L_lw_103
L_lwdone_104:
    ds_read_b32 v4, v38 offset:0
    ds_read_b32 v5, v38 offset:256
    ds_read_b32 v6, v38 offset:512
    ds_read_b32 v7, v38 offset:768
    ds_read_b32 v8, v38 offset:1024
    ds_read_b32 v9, v38 offset:1280
    ds_read_b32 v10, v38 offset:1536
    ds_read_b32 v11, v38 offset:1792
    ds_read_b32 v12, v38 offset:2048
    ds_read_b32 v13, v38 offset:2304
    ds_read_b32 v14, v38 offset:2560
    ds_read_b32 v15, v38 offset:2816
    ds_read_b32 v16, v38 offset:3072
    ds_read_b32 v17, v38 offset:3328
    ds_read_b32 v18, v38 offset:3584
    ds_read_b32 v19, v38 offset:3840
    s_waitcnt lgkmcnt(8)
    v_pk_add_f32 v[4:5], v[4:5], v[8:9]
    v_pk_add_f32 v[6:7], v[6:7], v[10:11]
    s_waitcnt lgkmcnt(0)
    v_pk_add_f32 v[12:13], v[12:13], v[16:17]
    v_pk_add_f32 v[14:15], v[14:15], v[18:19]
    v_pk_add_f32 v[4:5], v[4:5], v[12:13]
    v_pk_add_f32 v[6:7], v[6:7], v[14:15]
    v_cvt_pk_bf16_f32 v8, v4, v5
    v_mov_b32 v9, s63
    v_cvt_pk_bf16_f32 v10, v6, v7
    v_mov_b32 v11, s63
    buffer_store_dwordx4 v[8:11], v39, s[40:43], s75 offen sc1
L_nopub_102:
    s_branch L_h_common
L_h_mod:
    s_mov_b32 s44, s22
    s_mov_b32 s45, s23
    s_mov_b32 s46, 4096
    s_mov_b32 s47, 0x20000
    s_mov_b32 s32, s24
    s_mov_b32 s33, s25
    s_mov_b32 s34, 3145728
    s_mov_b32 s35, 0x20000
    s_lshl_b32 s74, s69, 8
    v_lshl_add_u32 v8, v0, 2, s74
    buffer_load_dword v4, v8, s[44:47], 0 offen offset:0
    buffer_load_dword v5, v8, s[44:47], 0 offen offset:1024
    buffer_load_dword v6, v8, s[44:47], 0 offen offset:2048
    buffer_load_dword v7, v8, s[44:47], 0 offen offset:3072
    s_lshl_b32 s75, s64, 7
    s_mul_i32 s73, s69, 786432
    s_add_u32 s73, s73, s75
    v_mul_u32_u24 v3, 49152, v2
    v_lshl_add_u32 v3, v1, 3, v3
    v_add_u32 v3, s73, v3
    s_mov_b32 s74, 0
    buffer_load_dwordx2 v[40:41], v3, s[32:35], s74 offen nt
    s_mov_b32 s74, 6144
    buffer_load_dwordx2 v[42:43], v3, s[32:35], s74 offen nt
    s_mov_b32 s74, 12288
    buffer_load_dwordx2 v[44:45], v3, s[32:35], s74 offen nt
    s_mov_b32 s74, 18432
    buffer_load_dwordx2 v[46:47], v3, s[32:35], s74 offen nt
    s_mov_b32 s74, 24576
    buffer_load_dwordx2 v[48:49], v3, s[32:35], s74 offen nt
    s_mov_b32 s74, 30720
    buffer_load_dwordx2 v[50:51], v3, s[32:35], s74 offen nt
    s_barrier
    s_mov_b32 s74, 36864
    buffer_load_dwordx2 v[52:53], v3, s[32:35], s74 offen nt
    s_mov_b32 s74, 43008
    buffer_load_dwordx2 v[54:55], v3, s[32:35], s74 offen nt
    s_mov_b32 s74, 196608
    buffer_load_dwordx2 v[56:57], v3, s[32:35], s74 offen nt
    s_mov_b32 s74, 202752
    buffer_load_dwordx2 v[58:59], v3, s[32:35], s74 offen nt
    s_mov_b32 s74, 208896
    buffer_load_dwordx2 v[60:61], v3, s[32:35], s74 offen nt
    s_mov_b32 s74, 215040
    buffer_load_dwordx2 v[62:63], v3, s[32:35], s74 offen nt
    s_mov_b32 s74, 221184
    buffer_load_dwordx2 v[64:65], v3, s[32:35], s74 offen nt
    s_mov_b32 s74, 227328
    buffer_load_dwordx2 v[66:67], v3, s[32:35], s74 offen nt
    s_mov_b32 s74, 233472
    buffer_load_dwordx2 v[68:69], v3, s[32:35], s74 offen nt
    s_mov_b32 s74, 239616
    buffer_load_dwordx2 v[70:71], v3, s[32:35], s74 offen nt
    s_mov_b32 s74, 393216
    buffer_load_dwordx2 v[72:73], v3, s[32:35], s74 offen nt
    s_mov_b32 s74, 399360
    buffer_load_dwordx2 v[74:75], v3, s[32:35], s74 offen nt
    s_mov_b32 s74, 405504
    buffer_load_dwordx2 v[76:77], v3, s[32:35], s74 offen nt
    s_mov_b32 s74, 411648
    buffer_load_dwordx2 v[78:79], v3, s[32:35], s74 offen nt
    s_mov_b32 s74, 417792
    buffer_load_dwordx2 v[80:81], v3, s[32:35], s74 offen nt
    s_mov_b32 s74, 423936
    buffer_load_dwordx2 v[82:83], v3, s[32:35], s74 offen nt
    s_mov_b32 s74, 430080
    buffer_load_dwordx2 v[84:85], v3, s[32:35], s74 offen nt
    s_mov_b32 s74, 436224
    buffer_load_dwordx2 v[86:87], v3, s[32:35], s74 offen nt
    s_mov_b32 s74, 589824
    buffer_load_dwordx2 v[88:89], v3, s[32:35], s74 offen nt
    s_mov_b32 s74, 595968
    buffer_load_dwordx2 v[90:91], v3, s[32:35], s74 offen nt
    s_mov_b32 s74, 602112
    buffer_load_dwordx2 v[92:93], v3, s[32:35], s74 offen nt
    s_mov_b32 s74, 608256
    buffer_load_dwordx2 v[94:95], v3, s[32:35], s74 offen nt
    s_mov_b32 s74, 614400
    buffer_load_dwordx2 v[96:97], v3, s[32:35], s74 offen nt
    s_mov_b32 s74, 620544
    buffer_load_dwordx2 v[98:99], v3, s[32:35], s74 offen nt
    s_mov_b32 s74, 626688
    buffer_load_dwordx2 v[100:101], v3, s[32:35], s74 offen nt
    s_waitcnt lgkmcnt(0)
    s_add_u32 s63, s63, 2654435769
    s_mov_b32 s74, 632832
    buffer_load_dwordx2 v[102:103], v3, s[32:35], s74 offen nt
    v_and_b32 v36, 3, v0
    v_mul_u32_u24 v36, 1088, v36
    v_lshl_add_u32 v36, v2, 4, v36
    s_lshl_b32 s74, s69, 8
    s_add_u32 s74, s74, 132096
    v_add_u32 v36, s74, v36
    v_lshlrev_b32 v38, 4, v0
    v_add_u32 v38, 136448, v38
    s_lshl_b32 s74, s69, 10
    v_add_u32 v37, s74, v38
    v_lshlrev_b32 v39, 6, v1
    v_lshl_add_u32 v39, v2, 4, v39
    s_waitcnt vmcnt(32)
    v_lshlrev_b32 v8, 16, v4
    v_and_b32 v9, 0xffff0000, v4
    v_lshlrev_b32 v10, 16, v5
    v_and_b32 v11, 0xffff0000, v5
    v_lshlrev_b32 v12, 16, v6
    v_and_b32 v13, 0xffff0000, v6
    v_lshlrev_b32 v14, 16, v7
    v_and_b32 v15, 0xffff0000, v7
    v_mul_f32 v16, 0xbfb8aa3b, v8
    v_mul_f32 v17, 0xbfb8aa3b, v9
    v_mul_f32 v18, 0xbfb8aa3b, v10
    v_mul_f32 v19, 0xbfb8aa3b, v11
    v_mul_f32 v20, 0xbfb8aa3b, v12
    v_mul_f32 v21, 0xbfb8aa3b, v13
    v_mul_f32 v22, 0xbfb8aa3b, v14
    v_mul_f32 v23, 0xbfb8aa3b, v15
    v_exp_f32 v16, v16
    v_exp_f32 v17, v17
    v_exp_f32 v18, v18
    v_exp_f32 v19, v19
    v_exp_f32 v20, v20
    v_exp_f32 v21, v21
    v_exp_f32 v22, v22
    v_exp_f32 v23, v23
    v_add_f32 v16, 1.0, v16
    v_add_f32 v17, 1.0, v17
    v_add_f32 v18, 1.0, v18
    v_add_f32 v19, 1.0, v19
    v_add_f32 v20, 1.0, v20
    v_add_f32 v21, 1.0, v21
    v_add_f32 v22, 1.0, v22
    v_add_f32 v23, 1.0, v23
    v_rcp_f32 v24, v16
    v_rcp_f32 v25, v17
    v_rcp_f32 v26, v18
    v_rcp_f32 v27, v19
    v_rcp_f32 v28, v20
    v_rcp_f32 v29, v21
    v_rcp_f32 v30, v22
    v_rcp_f32 v31, v23
    v_mul_f32 v152, v8, v24
    v_mul_f32 v153, v9, v25
    v_mul_f32 v154, v10, v26
    v_mul_f32 v155, v11, v27
    v_mul_f32 v156, v12, v28
    v_mul_f32 v157, v13, v29
    v_mul_f32 v158, v14, v30
    v_mul_f32 v159, v15, v31
    v_fma_f32 v160, -v152, v16, v8
    v_fma_f32 v161, -v153, v17, v9
    v_fma_f32 v162, -v154, v18, v10
    v_fma_f32 v163, -v155, v19, v11
    v_fma_f32 v164, -v156, v20, v12
    v_fma_f32 v165, -v157, v21, v13
    v_fma_f32 v166, -v158, v22, v14
    v_fma_f32 v167, -v159, v23, v15
    v_fma_f32 v152, v160, v24, v152
    v_fma_f32 v153, v161, v25, v153
    v_fma_f32 v154, v162, v26, v154
    v_fma_f32 v155, v163, v27, v155
    v_fma_f32 v156, v164, v28, v156
    v_fma_f32 v157, v165, v29, v157
    v_fma_f32 v158, v166, v30, v158
    v_fma_f32 v159, v167, v31, v159
    v_div_fixup_f32 v8, v152, v16, v8
    v_div_fixup_f32 v9, v153, v17, v9
    v_div_fixup_f32 v10, v154, v18, v10
    v_div_fixup_f32 v11, v155, v19, v11
    v_div_fixup_f32 v12, v156, v20, v12
    v_div_fixup_f32 v13, v157, v21, v13
    v_div_fixup_f32 v14, v158, v22, v14
    v_div_fixup_f32 v15, v159, v23, v15
    v_cvt_pk_bf16_f32 v4, v8, v9
    v_cvt_pk_bf16_f32 v5, v10, v11
    v_cvt_pk_bf16_f32 v6, v12, v13
    v_cvt_pk_bf16_f32 v7, v14, v15
    s_lshl_b32 s74, s69, 8
    s_add_u32 s74, s74, 132096
    v_lshl_add_u32 v35, v0, 2, s74
    ds_write_b32 v35, v4 offset:0
    ds_write_b32 v35, v5 offset:1088
    ds_write_b32 v35, v6 offset:2176
    ds_write_b32 v35, v7 offset:3264
    s_waitcnt vmcnt(24)
    v_perm_b32 v104, v42, v40, s70
    v_perm_b32 v105, v46, v44, s70
    v_perm_b32 v106, v50, v48, s70
    v_perm_b32 v107, v54, v52, s70
    v_perm_b32 v108, v42, v40, s71
    v_perm_b32 v109, v46, v44, s71
    v_perm_b32 v110, v50, v48, s71
    v_perm_b32 v111, v54, v52, s71
    v_perm_b32 v112, v43, v41, s70
    v_perm_b32 v113, v47, v45, s70
    v_perm_b32 v114, v51, v49, s70
    v_perm_b32 v115, v55, v53, s70
    v_perm_b32 v116, v43, v41, s71
    v_perm_b32 v117, v47, v45, s71
    v_perm_b32 v118, v51, v49, s71
    v_perm_b32 v119, v55, v53, s71
    s_waitcnt vmcnt(16)
    v_perm_b32 v120, v58, v56, s70
    v_perm_b32 v121, v62, v60, s70
    v_perm_b32 v122, v66, v64, s70
    v_perm_b32 v123, v70, v68, s70
    v_perm_b32 v124, v58, v56, s71
    v_perm_b32 v125, v62, v60, s71
    v_perm_b32 v126, v66, v64, s71
    v_perm_b32 v127, v70, v68, s71
    v_perm_b32 v128, v59, v57, s70
    v_perm_b32 v129, v63, v61, s70
    v_perm_b32 v130, v67, v65, s70
    v_perm_b32 v131, v71, v69, s70
    v_perm_b32 v132, v59, v57, s71
    v_perm_b32 v133, v63, v61, s71
    v_perm_b32 v134, v67, v65, s71
    v_perm_b32 v135, v71, v69, s71
    s_waitcnt vmcnt(8)
    v_perm_b32 v136, v74, v72, s70
    v_perm_b32 v137, v78, v76, s70
    v_perm_b32 v138, v82, v80, s70
    v_perm_b32 v139, v86, v84, s70
    v_perm_b32 v140, v74, v72, s71
    v_perm_b32 v141, v78, v76, s71
    v_perm_b32 v142, v82, v80, s71
    v_perm_b32 v143, v86, v84, s71
    v_perm_b32 v144, v75, v73, s70
    v_perm_b32 v145, v79, v77, s70
    v_perm_b32 v146, v83, v81, s70
    v_perm_b32 v147, v87, v85, s70
    v_perm_b32 v148, v75, v73, s71
    v_perm_b32 v149, v79, v77, s71
    v_perm_b32 v150, v83, v81, s71
    v_perm_b32 v151, v87, v85, s71
    s_waitcnt vmcnt(0)
    v_perm_b32 v152, v90, v88, s70
    v_perm_b32 v153, v94, v92, s70
    v_perm_b32 v154, v98, v96, s70
    v_perm_b32 v155, v102, v100, s70
    v_perm_b32 v156, v90, v88, s71
    v_perm_b32 v157, v94, v92, s71
    v_perm_b32 v158, v98, v96, s71
    v_perm_b32 v159, v102, v100, s71
    v_perm_b32 v160, v91, v89, s70
    v_perm_b32 v161, v95, v93, s70
    v_perm_b32 v162, v99, v97, s70
    v_perm_b32 v163, v103, v101, s70
    v_perm_b32 v164, v91, v89, s71
    v_perm_b32 v165, v95, v93, s71
    v_perm_b32 v166, v99, v97, s71
    v_perm_b32 v167, v103, v101, s71
    ds_read_b128 v[20:23], v36 offset:0
    ds_read_b128 v[24:27], v36 offset:64
    ds_read_b128 v[28:31], v36 offset:128
    ds_read_b128 v[32:35], v36 offset:192
    s_waitcnt lgkmcnt(3)
    v_mfma_f32_16x16x32_bf16 v[4:7], v[20:23], v[104:107], 0
    v_mfma_f32_16x16x32_bf16 v[8:11], v[20:23], v[108:111], 0
    v_mfma_f32_16x16x32_bf16 v[12:15], v[20:23], v[112:115], 0
    v_mfma_f32_16x16x32_bf16 v[16:19], v[20:23], v[116:119], 0
    s_waitcnt lgkmcnt(2)
    v_mfma_f32_16x16x32_bf16 v[4:7], v[24:27], v[120:123], v[4:7]
    v_mfma_f32_16x16x32_bf16 v[8:11], v[24:27], v[124:127], v[8:11]
    v_mfma_f32_16x16x32_bf16 v[12:15], v[24:27], v[128:131], v[12:15]
    v_mfma_f32_16x16x32_bf16 v[16:19], v[24:27], v[132:135], v[16:19]
    s_waitcnt lgkmcnt(1)
    v_mfma_f32_16x16x32_bf16 v[4:7], v[28:31], v[136:139], v[4:7]
    v_mfma_f32_16x16x32_bf16 v[8:11], v[28:31], v[140:143], v[8:11]
    v_mfma_f32_16x16x32_bf16 v[12:15], v[28:31], v[144:147], v[12:15]
    v_mfma_f32_16x16x32_bf16 v[16:19], v[28:31], v[148:151], v[16:19]
    s_waitcnt lgkmcnt(0)
    v_mfma_f32_16x16x32_bf16 v[4:7], v[32:35], v[152:155], v[4:7]
    v_mfma_f32_16x16x32_bf16 v[8:11], v[32:35], v[156:159], v[8:11]
    v_mfma_f32_16x16x32_bf16 v[12:15], v[32:35], v[160:163], v[12:15]
    v_mfma_f32_16x16x32_bf16 v[16:19], v[32:35], v[164:167], v[16:19]
    s_mov_b32 exec_lo, 0xffff
    s_mov_b32 exec_hi, 0x0
    s_nop 2
    ds_write_b128 v37, v[4:7] offset:0
    ds_write_b128 v37, v[8:11] offset:256
    ds_write_b128 v37, v[12:15] offset:512
    ds_write_b128 v37, v[16:19] offset:768
    s_mov_b64 exec, -1
    s_lshl_b32 s74, s69, 2
    s_add_u32 s74, s74, 140544
    v_mov_b32 v20, s74
    v_mov_b32 v21, 1
    s_mov_b64 exec, 1
    ds_write_b32 v20, v21
    s_mov_b64 exec, -1
    s_cmp_lg_u32 s69, 0
    s_cbranch_scc1 L_nopub_105
    s_lshl_b32 s75, s64, 8
    v_lshlrev_b32 v38, 4, v1
    v_lshl_add_u32 v39, v2, 13, v38
    v_lshl_add_u32 v38, v2, 2, v38
    v_add_u32 v38, 136448, v38
    s_add_u32 s75, s75, 16384
    v_mov_b32 v24, 140544
    s_mov_b32 s72, 64000000
L_lw_106:
    ds_read_b128 v[20:23], v24
    s_waitcnt lgkmcnt(0)
    v_and_b32 v20, v20, v22
    v_and_b32 v21, v21, v23
    v_and_b32 v20, v20, v21
    v_cmp_ne_u32 vcc, 1, v20
    s_nop 0
    s_cbranch_vccz L_lwdone_107
    s_sub_u32 s72, s72, 1
    s_cmp_lg_u32 s72, 0
    s_cbranch_scc1 L_lw_106
L_lwdone_107:
    ds_read_b32 v4, v38 offset:0
    ds_read_b32 v5, v38 offset:256
    ds_read_b32 v6, v38 offset:512
    ds_read_b32 v7, v38 offset:768
    ds_read_b32 v8, v38 offset:1024
    ds_read_b32 v9, v38 offset:1280
    ds_read_b32 v10, v38 offset:1536
    ds_read_b32 v11, v38 offset:1792
    ds_read_b32 v12, v38 offset:2048
    ds_read_b32 v13, v38 offset:2304
    ds_read_b32 v14, v38 offset:2560
    ds_read_b32 v15, v38 offset:2816
    ds_read_b32 v16, v38 offset:3072
    ds_read_b32 v17, v38 offset:3328
    ds_read_b32 v18, v38 offset:3584
    ds_read_b32 v19, v38 offset:3840
    s_waitcnt lgkmcnt(8)
    v_pk_add_f32 v[4:5], v[4:5], v[8:9]
    v_pk_add_f32 v[6:7], v[6:7], v[10:11]
    s_waitcnt lgkmcnt(0)
    v_pk_add_f32 v[12:13], v[12:13], v[16:17]
    v_pk_add_f32 v[14:15], v[14:15], v[18:19]
    v_pk_add_f32 v[4:5], v[4:5], v[12:13]
    v_pk_add_f32 v[6:7], v[6:7], v[14:15]
    v_cvt_pk_bf16_f32 v8, v4, v5
    v_mov_b32 v9, s63
    v_cvt_pk_bf16_f32 v10, v6, v7
    v_mov_b32 v11, s63
    buffer_store_dwordx4 v[8:11], v39, s[40:43], s75 offen sc1
L_nopub_105:
    s_branch L_h_common
L_h_other:
    s_waitcnt lgkmcnt(0)
    s_load_dword s63, s[30:31], 0
    s_mov_b32 s40, s30
    s_mov_b32 s41, s31
    s_mov_b32 s42, 2097152
    s_mov_b32 s43, 0x20000
    s_setprio 3
    s_mov_b64 vcc, 0
    s_cmp_eq_u32 s61, 4
    s_cbranch_scc1 L_h_mod
    s_cmp_eq_u32 s61, 3
    s_cbranch_scc1 L_h_f
    s_cmp_eq_u32 s61, 2
    s_cbranch_scc1 L_h_wo
    s_barrier
    s_cmp_lg_u32 s69, 1
    s_cbranch_scc1 L_novt
    s_mov_b32 s36, s8
    s_mov_b32 s37, s9
    s_mov_b32 s38, 67108864
    s_mov_b32 s39, 0x20000
    v_lshlrev_b32 v8, 24, v2
    v_lshl_add_u32 v8, v1, 17, v8
    s_lshl_b32 s74, s66, 21
    buffer_load_dword v9, v8, s[36:39], s74 offen nt
L_novt:
    s_waitcnt lgkmcnt(0)
    s_add_u32 s63, s63, 2654435769
L_h_common:
    s_setprio 3
    s_cmp_lg_u32 s69, 0
    s_cbranch_scc1 L_h_mlwait
    s_lshl_b32 s73, s66, 15
    s_lshl_b32 s74, s65, 13
    s_add_u32 s73, s73, s74
    s_and_b32 s74, s62, 7
    s_lshl_b32 s74, s74, 10
    s_add_u32 s73, s73, s74
    s_add_u32 s73, s73, 1310720
    v_lshlrev_b32 v32, 7, v0
    s_mov_b64 exec, 0xff
    buffer_load_dword v28, v32, s[40:43], s73 offen sc1
    s_mov_b64 exec, -1
    v_mov_b32 v5, 140564
    s_mov_b32 s72, 64000000
L_lw_108:
    ds_read_b32 v6, v5
    s_waitcnt lgkmcnt(0)
    v_cmp_ne_u32 vcc, 1, v6
    s_nop 0
    s_cbranch_vccz L_lwdone_109
    s_sleep 4
    s_sub_u32 s72, s72, 1
    s_cmp_lg_u32 s72, 0
    s_cbranch_scc1 L_lw_108
L_lwdone_109:
    s_lshl_b32 s75, s65, 14
    s_lshl_b32 s74, s66, 11
    s_add_u32 s75, s75, s74
    s_add_u32 s75, s75, 65536
    v_lshlrev_b32 v34, 4, v0
    v_lshlrev_b32 v35, 3, v0
    v_add_u32 v35, 131072, v35
    s_waitcnt vmcnt(0)
    s_mov_b32 s72, 1000000
L_pp_110:
    buffer_load_dwordx4 v[8:11], v34, s[40:43], s75 offen offset:0 sc1
    buffer_load_dwordx4 v[12:15], v34, s[40:43], s75 offen offset:1024 sc1
    s_waitcnt vmcnt(0)
    v_cmp_ne_u32 s[76:77], s63, v9
    v_cmp_ne_u32 vcc, s63, v11
    s_nop 0
    s_or_b64 s[76:77], s[76:77], vcc
    v_cmp_ne_u32 vcc, s63, v13
    s_nop 0
    s_or_b64 s[76:77], s[76:77], vcc
    v_cmp_ne_u32 vcc, s63, v15
    s_nop 0
    s_or_b64 s[76:77], s[76:77], vcc
    s_cmp_eq_u64 s[76:77], 0
    s_cbranch_scc1 L_ppdone_112
    s_sleep 4
    s_sub_u32 s72, s72, 1
    s_cmp_lg_u32 s72, 0
    s_cbranch_scc1 L_pp_110
L_ppdone_112:
    ds_write2_b32 v35, v8, v10 offset0:0 offset1:1
    ds_write2_b32 v35, v12, v14 offset0:128 offset1:129
L_ppend_111:
    v_mov_b32 v5, 140560
    v_mov_b32 v6, 1
    s_mov_b64 exec, 1
    ds_write_b32 v5, v6
    s_mov_b64 exec, -1
    s_waitcnt vmcnt(0)
L_h_ml:
    v_mov_b32 v28, -1
    v_mov_b32 v29, -1
    v_mov_b32 v30, -1
    v_mov_b32 v31, -1
    v_lshlrev_b32 v32, 8, v0
    s_lshl_b32 s73, s66, 15
    s_bfe_u32 s74, s62, 0x10002
    s_lshl_b32 s74, s74, 14
    s_add_u32 s73, s73, s74
    s_lshl_b32 s74, s65, 6
    s_add_u32 s73, s73, s74
    s_and_b32 s74, s62, 3
    s_lshl_b32 s74, s74, 4
    s_add_u32 s73, s73, s74
    s_add_u32 s73, s73, 1310720
    buffer_store_dwordx4 v[28:31], v32, s[40:43], s73 offen
    v_and_b32 v34, 31, v0
    v_lshlrev_b32 v33, 3, v34
    v_add_u32 v33, 140672, v33
    v_lshlrev_b32 v34, 4, v34
    v_lshlrev_b32 v35, 3, v0
    v_add_u32 v35, 140608, v35
    s_lshl_b32 s73, s62, 6
    s_add_u32 s73, s73, 131072
    s_and_b32 s75, s73, 0xfffffe00
    v_mov_b32 v13, s63
    v_mov_b32 v15, s63
    v_mov_b32 v5, 140568
    s_mov_b32 s72, 64000000
L_lw_113:
    ds_read_b32 v6, v5
    s_waitcnt lgkmcnt(0)
    v_cmp_ne_u32 vcc, 8, v6
    s_nop 0
    s_cbranch_vccz L_lwdone_114
    s_sleep 2
    s_sub_u32 s72, s72, 1
    s_cmp_lg_u32 s72, 0
    s_cbranch_scc1 L_lw_113
L_lwdone_114:
    ds_read_b64 v[4:5], v33
    s_waitcnt lgkmcnt(0)
    v_mov_b32 v12, v4
    s_nop 1
    v_max_f32_dpp v12, v12, v12 row_ror:4 row_mask:0xf bank_mask:0xf
    s_nop 1
    v_max_f32_dpp v12, v12, v12 row_ror:8 row_mask:0xf bank_mask:0xf
    v_mov_b32 v20, v12
    s_nop 1
    v_permlane16_swap_b32 v12, v20
    v_max_f32 v12, v12, v20
    v_sub_f32 v21, v4, v12
    v_mul_f32 v21, 0x3fb8aa3b, v21
    v_exp_f32 v21, v21
    s_nop 0
    v_mul_f32 v14, v21, v5
    s_nop 1
    v_add_f32_dpp v14, v14, v14 row_ror:4 row_mask:0xf bank_mask:0xf
    s_nop 1
    v_add_f32_dpp v14, v14, v14 row_ror:8 row_mask:0xf bank_mask:0xf
    v_mov_b32 v20, v14
    s_nop 1
    v_permlane16_swap_b32 v14, v20
    v_add_f32 v14, v14, v20
    s_getreg_b32 s58, hwreg(HW_REG_XCC_ID)
    s_and_b32 s58, s58, 0xf
    v_or_b32 v12, s58, v12
    s_waitcnt vmcnt(0)
    s_mov_b64 exec, 0xf
    buffer_store_dwordx4 v[12:15], v34, s[40:43], s73 offen sc1
    s_mov_b64 exec, -1
    v_mov_b32 v5, 140596
    s_mov_b32 s72, 64000000
L_lw_115:
    ds_read_b32 v6, v5
    s_waitcnt lgkmcnt(0)
    v_cmp_ne_u32 vcc, 1, v6
    s_nop 0
    s_cbranch_vccz L_lwdone_116
    s_sleep 2
    s_sub_u32 s72, s72, 1
    s_cmp_lg_u32 s72, 0
    s_cbranch_scc1 L_lw_115
L_lwdone_116:
    s_mov_b32 s72, 1000000
L_pp_117:
    buffer_load_dwordx4 v[24:27], v34, s[40:43], s75 offen sc1
    s_waitcnt vmcnt(0)
    v_cmp_ne_u32 s[76:77], s63, v25
    v_cmp_ne_u32 vcc, s63, v27
    s_nop 0
    s_or_b64 s[76:77], s[76:77], vcc
    s_cmp_eq_u64 s[76:77], 0
    s_cbranch_scc1 L_ppdone_119
    s_sleep 4
    s_sub_u32 s72, s72, 1
    s_cmp_lg_u32 s72, 0
    s_cbranch_scc1 L_pp_117
L_ppdone_119:
    v_and_b32 v4, 0xffff0000, v24
    v_mov_b32 v5, v26
L_ppend_118:
    v_mov_b32 v16, v4
    s_nop 1
    v_max_f32_dpp v16, v16, v16 row_ror:4 row_mask:0xf bank_mask:0xf
    s_nop 1
    v_max_f32_dpp v16, v16, v16 row_ror:8 row_mask:0xf bank_mask:0xf
    v_mov_b32 v20, v16
    s_nop 1
    v_permlane16_swap_b32 v16, v20
    v_max_f32 v16, v16, v20
    v_sub_f32 v21, v4, v16
    v_mul_f32 v21, 0x3fb8aa3b, v21
    v_exp_f32 v21, v21
    s_nop 0
    v_mul_f32 v17, v21, v5
    s_nop 1
    v_add_f32_dpp v17, v17, v17 row_ror:4 row_mask:0xf bank_mask:0xf
    s_nop 1
    v_add_f32_dpp v17, v17, v17 row_ror:8 row_mask:0xf bank_mask:0xf
    v_mov_b32 v20, v17
    s_nop 1
    v_permlane16_swap_b32 v17, v20
    v_add_f32 v17, v17, v20
    v_rcp_f32 v17, v17
    s_mov_b64 exec, 0xf
    ds_write_b64 v35, v[16:17]
    s_mov_b64 exec, -1
    v_mov_b32 v5, 140576
    v_mov_b32 v6, 1
    s_mov_b64 exec, 1
    ds_write_b32 v5, v6
    s_mov_b64 exec, -1
    s_lshl_b32 s73, s66, 15
    s_lshl_b32 s74, s65, 13
    s_add_u32 s73, s73, s74
    s_and_b32 s74, s62, 7
    s_lshl_b32 s74, s74, 10
    s_add_u32 s73, s73, s74
    s_add_u32 s73, s73, 1310720
    v_lshlrev_b32 v32, 7, v0
    s_mov_b64 exec, 0xff
    buffer_load_dword v28, v32, s[40:43], s73 offen sc1
    s_mov_b64 exec, -1
    s_waitcnt vmcnt(0)
    s_cmp_lg_u32 s61, 2
    s_cbranch_scc1 L_h_mlwait
    v_and_b32 v34, 7, v0
    v_lshlrev_b32 v34, 6, v34
    v_bfe_u32 v35, v0, 3, 2
    v_lshl_add_u32 v34, v35, 12, v34
    s_lshl_b32 s75, s66, 9
    s_add_u32 s75, s75, 131072
    s_mov_b32 s72, 1000000
L_pp_120:
    buffer_load_dwordx2 v[24:25], v34, s[40:43], s75 offen sc1
    s_waitcnt vmcnt(0)
    v_cmp_ne_u32 s[76:77], s63, v25
    s_nop 0
    s_cmp_eq_u64 s[76:77], 0
    s_cbranch_scc1 L_ppdone_122
    s_sleep 4
    s_sub_u32 s72, s72, 1
    s_cmp_lg_u32 s72, 0
    s_cbranch_scc1 L_pp_120
L_ppdone_122:
L_ppend_121:
    v_and_b32 v24, 0xffff, v24
    v_cmp_ne_u32 vcc, s58, v24
    s_nop 0
    s_cmp_eq_u64 vcc, 0
    s_cselect_b32 s74, 1048576, 0
    v_mov_b32 v5, 140604
    v_mov_b32 v6, s74
    ds_write_b32 v5, v6
    v_mov_b32 v5, 140588
    v_mov_b32 v6, 1
    s_mov_b64 exec, 1
    ds_add_u32 v5, v6
    s_mov_b64 exec, -1
L_h_mlwait:
    s_cmp_eq_u32 s61, 2
    s_cbranch_scc1 L_hpost_w
    s_cmp_eq_u32 s61, 3
    s_cbranch_scc1 L_h_f2
    s_branch L_fin
L_h_wo:
    s_mov_b32 s32, s12
    s_mov_b32 s33, s13
    s_mov_b32 s34, 4194304
    s_mov_b32 s35, 0x20000
    s_lshl_b32 s73, s66, 19
    s_lshl_b32 s74, s69, 11
    s_add_u32 s73, s73, s74
    s_lshl_b32 s74, s64, 7
    s_add_u32 s73, s73, s74
    v_lshlrev_b32 v3, 14, v2
    v_lshl_add_u32 v3, v1, 3, v3
    v_add_u32 v3, s73, v3
    s_mov_b32 s74, 0
    buffer_load_dwordx2 v[40:41], v3, s[32:35], s74 offen nt
    s_mov_b32 s74, 131072
    buffer_load_dwordx2 v[42:43], v3, s[32:35], s74 offen nt
    s_mov_b32 s74, 262144
    buffer_load_dwordx2 v[44:45], v3, s[32:35], s74 offen nt
    s_mov_b32 s74, 393216
    buffer_load_dwordx2 v[46:47], v3, s[32:35], s74 offen nt
    s_mov_b32 s74, 8192
    buffer_load_dwordx2 v[48:49], v3, s[32:35], s74 offen nt
    s_mov_b32 s74, 139264
    buffer_load_dwordx2 v[50:51], v3, s[32:35], s74 offen nt
    s_barrier
    s_mov_b32 s74, 270336
    buffer_load_dwordx2 v[52:53], v3, s[32:35], s74 offen nt
    s_mov_b32 s74, 401408
    buffer_load_dwordx2 v[54:55], v3, s[32:35], s74 offen nt
    s_mov_b32 s74, 65536
    buffer_load_dwordx2 v[56:57], v3, s[32:35], s74 offen nt
    s_mov_b32 s74, 196608
    buffer_load_dwordx2 v[58:59], v3, s[32:35], s74 offen nt
    s_mov_b32 s74, 327680
    buffer_load_dwordx2 v[60:61], v3, s[32:35], s74 offen nt
    s_mov_b32 s74, 458752
    buffer_load_dwordx2 v[62:63], v3, s[32:35], s74 offen nt
    s_mov_b32 s74, 73728
    buffer_load_dwordx2 v[64:65], v3, s[32:35], s74 offen nt
    s_mov_b32 s74, 204800
    buffer_load_dwordx2 v[66:67], v3, s[32:35], s74 offen nt
    s_mov_b32 s74, 335872
    buffer_load_dwordx2 v[68:69], v3, s[32:35], s74 offen nt
    s_mov_b32 s74, 466944
    buffer_load_dwordx2 v[70:71], v3, s[32:35], s74 offen nt
    s_mov_b32 s74, 1024
    buffer_load_dwordx2 v[72:73], v3, s[32:35], s74 offen nt
    s_mov_b32 s74, 132096
    buffer_load_dwordx2 v[74:75], v3, s[32:35], s74 offen nt
    s_mov_b32 s74, 263168
    buffer_load_dwordx2 v[76:77], v3, s[32:35], s74 offen nt
    s_mov_b32 s74, 394240
    buffer_load_dwordx2 v[78:79], v3, s[32:35], s74 offen nt
    s_mov_b32 s74, 9216
    buffer_load_dwordx2 v[80:81], v3, s[32:35], s74 offen nt
    s_mov_b32 s74, 140288
    buffer_load_dwordx2 v[82:83], v3, s[32:35], s74 offen nt
    s_mov_b32 s74, 271360
    buffer_load_dwordx2 v[84:85], v3, s[32:35], s74 offen nt
    s_mov_b32 s74, 402432
    buffer_load_dwordx2 v[86:87], v3, s[32:35], s74 offen nt
    s_mov_b32 s74, 66560
    buffer_load_dwordx2 v[88:89], v3, s[32:35], s74 offen nt
    s_mov_b32 s74, 197632
    buffer_load_dwordx2 v[90:91], v3, s[32:35], s74 offen nt
    s_mov_b32 s74, 328704
    buffer_load_dwordx2 v[92:93], v3, s[32:35], s74 offen nt
    s_mov_b32 s74, 459776
    buffer_load_dwordx2 v[94:95], v3, s[32:35], s74 offen nt
    s_mov_b32 s74, 74752
    buffer_load_dwordx2 v[96:97], v3, s[32:35], s74 offen nt
    s_mov_b32 s74, 205824
    buffer_load_dwordx2 v[98:99], v3, s[32:35], s74 offen nt
    s_mov_b32 s74, 336896
    buffer_load_dwordx2 v[100:101], v3, s[32:35], s74 offen nt
    s_waitcnt lgkmcnt(0)
    s_add_u32 s63, s63, 2654435769
    s_mov_b32 s74, 467968
    buffer_load_dwordx2 v[102:103], v3, s[32:35], s74 offen nt
    s_waitcnt vmcnt(0)
    v_mov_b32 v8, 140588
    v_mov_b32 v9, 1
    s_mov_b64 exec, 1
    ds_add_u32 v8, v9
    s_mov_b64 exec, -1
    v_perm_b32 v104, v42, v40, s70
    v_perm_b32 v105, v46, v44, s70
    v_perm_b32 v106, v50, v48, s70
    v_perm_b32 v107, v54, v52, s70
    v_perm_b32 v108, v42, v40, s71
    v_perm_b32 v109, v46, v44, s71
    v_perm_b32 v110, v50, v48, s71
    v_perm_b32 v111, v54, v52, s71
    v_perm_b32 v112, v43, v41, s70
    v_perm_b32 v113, v47, v45, s70
    v_perm_b32 v114, v51, v49, s70
    v_perm_b32 v115, v55, v53, s70
    v_perm_b32 v116, v43, v41, s71
    v_perm_b32 v117, v47, v45, s71
    v_perm_b32 v118, v51, v49, s71
    v_perm_b32 v119, v55, v53, s71
    v_perm_b32 v120, v58, v56, s70
    v_perm_b32 v121, v62, v60, s70
    v_perm_b32 v122, v66, v64, s70
    v_perm_b32 v123, v70, v68, s70
    v_perm_b32 v124, v58, v56, s71
    v_perm_b32 v125, v62, v60, s71
    v_perm_b32 v126, v66, v64, s71
    v_perm_b32 v127, v70, v68, s71
    v_perm_b32 v128, v59, v57, s70
    v_perm_b32 v129, v63, v61, s70
    v_perm_b32 v130, v67, v65, s70
    v_perm_b32 v131, v71, v69, s70
    v_perm_b32 v132, v59, v57, s71
    v_perm_b32 v133, v63, v61, s71
    v_perm_b32 v134, v67, v65, s71
    v_perm_b32 v135, v71, v69, s71
    v_perm_b32 v136, v74, v72, s70
    v_perm_b32 v137, v78, v76, s70
    v_perm_b32 v138, v82, v80, s70
    v_perm_b32 v139, v86, v84, s70
    v_perm_b32 v140, v74, v72, s71
    v_perm_b32 v141, v78, v76, s71
    v_perm_b32 v142, v82, v80, s71
    v_perm_b32 v143, v86, v84, s71
    v_perm_b32 v144, v75, v73, s70
    v_perm_b32 v145, v79, v77, s70
    v_perm_b32 v146, v83, v81, s70
    v_perm_b32 v147, v87, v85, s70
    v_perm_b32 v148, v75, v73, s71
    v_perm_b32 v149, v79, v77, s71
    v_perm_b32 v150, v83, v81, s71
    v_perm_b32 v151, v87, v85, s71
    v_perm_b32 v152, v90, v88, s70
    v_perm_b32 v153, v94, v92, s70
    v_perm_b32 v154, v98, v96, s70
    v_perm_b32 v155, v102, v100, s70
    v_perm_b32 v156, v90, v88, s71
    v_perm_b32 v157, v94, v92, s71
    v_perm_b32 v158, v98, v96, s71
    v_perm_b32 v159, v102, v100, s71
    v_perm_b32 v160, v91, v89, s70
    v_perm_b32 v161, v95, v93, s70
    v_perm_b32 v162, v99, v97, s70
    v_perm_b32 v163, v103, v101, s70
    v_perm_b32 v164, v91, v89, s71
    v_perm_b32 v165, v95, v93, s71
    v_perm_b32 v166, v99, v97, s71
    v_perm_b32 v167, v103, v101, s71
    s_cmp_eq_u32 s69, 0
    s_cbranch_scc1 L_h_common
    s_cmp_lg_u32 s69, 3
    s_cbranch_scc1 L_hpost_w
    v_mov_b32 v5, 140564
    s_mov_b32 s72, 64000000
L_lw_123:
    ds_read_b32 v6, v5
    s_waitcnt lgkmcnt(0)
    v_cmp_ne_u32 vcc, 1, v6
    s_nop 0
    s_cbranch_vccz L_lwdone_124
    s_sleep 4
    s_sub_u32 s72, s72, 1
    s_cmp_lg_u32 s72, 0
    s_cbranch_scc1 L_lw_123
L_lwdone_124:
    s_getpc_b64 s[76:77]
L_pc_125:
    s_add_u32 s76, s76, L_v1done-L_pc_125
    s_addc_u32 s77, s77, (L_v1done-L_pc_125)>>32
    v_lshlrev_b32 v8, 7, v0
    v_cmp_gt_u32 vcc, L_kpost_f-L_v1done, v8
    s_nop 1
    v_cndmask_b32 v8, 0, v8, vcc
    global_load_dword v9, v8, s[76:77]
    v_mov_b32 v5, 140596
    s_mov_b32 s72, 64000000
L_lw_126:
    ds_read_b32 v6, v5
    s_waitcnt lgkmcnt(0)
    v_cmp_ne_u32 vcc, 1, v6
    s_nop 0
    s_cbranch_vccz L_lwdone_127
    s_sleep 4
    s_sub_u32 s72, s72, 1
    s_cmp_lg_u32 s72, 0
    s_cbranch_scc1 L_lw_126
L_lwdone_127:
    s_getpc_b64 s[76:77]
L_pc_128:
    s_add_u32 s76, s76, L_hpost_w-L_pc_128
    s_addc_u32 s77, s77, (L_hpost_w-L_pc_128)>>32
    v_lshlrev_b32 v10, 7, v0
    v_cmp_gt_u32 vcc, L_h_f-L_hpost_w, v10
    s_nop 1
    v_cndmask_b32 v10, 0, v10, vcc
    global_load_dword v11, v10, s[76:77]
    s_waitcnt vmcnt(0)
L_hpost_w:
    s_setprio 3
    v_and_b32 v36, 3, v0
    v_mul_u32_u24 v36, 1088, v36
    v_lshl_add_u32 v36, v2, 4, v36
    s_lshl_b32 s74, s69, 8
    s_add_u32 s74, s74, 132096
    v_add_u32 v36, s74, v36
    v_lshlrev_b32 v38, 4, v0
    v_add_u32 v38, 136448, v38
    s_lshl_b32 s74, s69, 10
    v_add_u32 v37, s74, v38
    v_lshlrev_b32 v39, 6, v1
    v_lshl_add_u32 v39, v2, 4, v39
    s_lshl_b32 s73, s66, 13
    s_lshl_b32 s74, s64, 10
    s_add_u32 s73, s73, s74
    s_add_u32 s73, s73, 786432
    v_lshlrev_b32 v42, 4, v0
    v_mov_b32 v44, -1
    v_mov_b32 v45, -1
    v_mov_b32 v46, -1
    v_mov_b32 v47, -1
    s_lshl_b32 s75, s66, 3
    s_add_u32 s75, s75, s64
    s_mul_i32 s75, s75, 7168
    s_mul_i32 s74, s69, 1792
    s_add_u32 s75, s75, s74
    s_add_u32 s75, s75, 851968
    v_mov_b32 v5, 140580
    s_mov_b32 s72, 64000000
L_lw_129:
    ds_read_b32 v6, v5
    s_waitcnt lgkmcnt(0)
    v_cmp_ne_u32 vcc, 8, v6
    s_nop 0
    s_cbranch_vccz L_lwdone_130
    s_sleep 2
    s_sub_u32 s72, s72, 1
    s_cmp_lg_u32 s72, 0
    s_cbranch_scc1 L_lw_129
L_lwdone_130:
    buffer_store_dwordx4 v[44:47], v42, s[40:43], s75 offen sc1
    buffer_store_dwordx4 v[44:47], v42, s[40:43], s75 offen offset:768 sc1
    v_mov_b32 v8, 140588
    s_mov_b32 s72, 64000000
L_lw_131:
    ds_read_b32 v9, v8
    s_waitcnt lgkmcnt(0)
    v_cmp_ne_u32 vcc, 5, v9
    s_nop 0
    s_cbranch_vccz L_lwdone_132
    s_sleep 1
    s_sub_u32 s72, s72, 1
    s_cmp_lg_u32 s72, 0
    s_cbranch_scc1 L_lw_131
L_lwdone_132:
    ds_read_b32 v9, v8 offset:16
    s_lshl_b32 s52, s66, 15
    s_lshl_b32 s74, s69, 12
    s_add_u32 s52, s52, s74
    s_add_u32 s52, s52, 262144
    s_waitcnt lgkmcnt(0)
    v_readfirstlane_b32 s74, v9
    s_nop 0
    s_add_u32 s52, s52, s74
    s_add_u32 s53, s52, 16384
    s_cmp_lg_u32 s74, 0
    s_cbranch_scc1 L_wloc
    v_lshlrev_b32 v10, 10, v2
    v_lshl_add_u32 v10, v1, 2, v10
    s_lshl_b32 s54, s66, 7
    s_add_u32 s54, s54, 196608
    s_mov_b32 s72, 1000000
L_pp_133:
    buffer_load_dword v11, v10, s[40:43], s54 offen sc1
    s_waitcnt vmcnt(0)
    v_cmp_ne_u32 s[76:77], s63, v11
    s_nop 0
    s_cmp_eq_u64 s[76:77], 0
    s_cbranch_scc1 L_ppdone_135
    s_sleep 2
    s_sub_u32 s72, s72, 1
    s_cmp_lg_u32 s72, 0
    s_cbranch_scc1 L_pp_133
L_ppdone_135:
L_ppend_134:
L_wloc:
    s_mov_b32 s72, 4000000
    s_mov_b32 s55, 0
    s_mov_b64 s[56:57], -1
    s_mov_b64 s[58:59], -1
L_wg:
    s_bitcmp1_b32 s55, 0
    s_cbranch_scc1 L_wgl_136
    s_mov_b64 exec, s[56:57]
    buffer_load_dwordx4 v[48:51], v42, s[40:43], s52 offen offset:0 sc1
    buffer_load_dwordx4 v[52:55], v42, s[40:43], s52 offen offset:1024 sc1
    buffer_load_dwordx4 v[56:59], v42, s[40:43], s52 offen offset:2048 sc1
    buffer_load_dwordx4 v[60:63], v42, s[40:43], s52 offen offset:3072 sc1
L_wgl_136:
    s_bitcmp1_b32 s55, 1
    s_cbranch_scc1 L_wgl_137
    s_mov_b64 exec, s[58:59]
    buffer_load_dwordx4 v[64:67], v42, s[40:43], s53 offen offset:0 sc1
    buffer_load_dwordx4 v[68:71], v42, s[40:43], s53 offen offset:1024 sc1
    buffer_load_dwordx4 v[72:75], v42, s[40:43], s53 offen offset:2048 sc1
    buffer_load_dwordx4 v[76:79], v42, s[40:43], s53 offen offset:3072 sc1
L_wgl_137:
    s_mov_b64 exec, -1
    s_waitcnt vmcnt(0)
    s_bitcmp1_b32 s55, 0
    s_cbranch_scc1 L_wgc_138
    v_max3_u32 v20, v48, v49, v50
    v_max3_u32 v21, v51, v52, v53
    v_max3_u32 v20, v20, v54, v55
    v_max3_u32 v21, v21, v56, v57
    v_max3_u32 v20, v20, v58, v59
    v_max3_u32 v21, v21, v60, v61
    v_max3_u32 v20, v20, v62, v63
    v_max_u32 v20, v20, v21
    v_cmp_eq_u32 vcc, -1, v20
    s_nop 0
    s_mov_b64 s[56:57], vcc
    s_cmp_eq_u32 s72, 1
    s_cbranch_scc1 L_wforce0
    s_cbranch_vccnz L_wgc_138
L_wforce0:
    v_mfma_f32_16x16x32_bf16 v[4:7], v[48:51], v[104:107], 0
    v_mfma_f32_16x16x32_bf16 v[8:11], v[48:51], v[108:111], 0
    v_mfma_f32_16x16x32_bf16 v[12:15], v[48:51], v[112:115], 0
    v_mfma_f32_16x16x32_bf16 v[16:19], v[48:51], v[116:119], 0
    v_mfma_f32_16x16x32_bf16 v[4:7], v[52:55], v[120:123], v[4:7]
    v_mfma_f32_16x16x32_bf16 v[8:11], v[52:55], v[124:127], v[8:11]
    v_mfma_f32_16x16x32_bf16 v[12:15], v[52:55], v[128:131], v[12:15]
    v_mfma_f32_16x16x32_bf16 v[16:19], v[52:55], v[132:135], v[16:19]
    v_mfma_f32_16x16x32_bf16 v[4:7], v[56:59], v[136:139], v[4:7]
    v_mfma_f32_16x16x32_bf16 v[8:11], v[56:59], v[140:143], v[8:11]
    v_mfma_f32_16x16x32_bf16 v[12:15], v[56:59], v[144:147], v[12:15]
    v_mfma_f32_16x16x32_bf16 v[16:19], v[56:59], v[148:151], v[16:19]
    v_mfma_f32_16x16x32_bf16 v[4:7], v[60:63], v[152:155], v[4:7]
    v_mfma_f32_16x16x32_bf16 v[8:11], v[60:63], v[156:159], v[8:11]
    v_mfma_f32_16x16x32_bf16 v[12:15], v[60:63], v[160:163], v[12:15]
    v_mfma_f32_16x16x32_bf16 v[16:19], v[60:63], v[164:167], v[16:19]
    s_bitset1_b32 s55, 0
    s_nop 3
    v_pk_add_f32 v[4:5], v[4:5], v[6:7]
    v_pk_add_f32 v[8:9], v[8:9], v[10:11]
    v_pk_add_f32 v[12:13], v[12:13], v[14:15]
    v_pk_add_f32 v[16:17], v[16:17], v[18:19]
    v_add_f32 v80, v4, v5
    v_add_f32 v81, v8, v9
    v_add_f32 v82, v12, v13
    v_add_f32 v83, v16, v17
L_wgc_138:
    s_bitcmp1_b32 s55, 1
    s_cbranch_scc1 L_wgc_139
    v_max3_u32 v20, v64, v65, v66
    v_max3_u32 v21, v67, v68, v69
    v_max3_u32 v20, v20, v70, v71
    v_max3_u32 v21, v21, v72, v73
    v_max3_u32 v20, v20, v74, v75
    v_max3_u32 v21, v21, v76, v77
    v_max3_u32 v20, v20, v78, v79
    v_max_u32 v20, v20, v21
    v_cmp_eq_u32 vcc, -1, v20
    s_nop 0
    s_mov_b64 s[58:59], vcc
    s_cmp_eq_u32 s72, 1
    s_cbranch_scc1 L_wforce1
    s_cbranch_vccnz L_wgc_139
L_wforce1:
    v_mfma_f32_16x16x32_bf16 v[4:7], v[64:67], v[104:107], 0
    v_mfma_f32_16x16x32_bf16 v[8:11], v[64:67], v[108:111], 0
    v_mfma_f32_16x16x32_bf16 v[12:15], v[64:67], v[112:115], 0
    v_mfma_f32_16x16x32_bf16 v[16:19], v[64:67], v[116:119], 0
    v_mfma_f32_16x16x32_bf16 v[4:7], v[68:71], v[120:123], v[4:7]
    v_mfma_f32_16x16x32_bf16 v[8:11], v[68:71], v[124:127], v[8:11]
    v_mfma_f32_16x16x32_bf16 v[12:15], v[68:71], v[128:131], v[12:15]
    v_mfma_f32_16x16x32_bf16 v[16:19], v[68:71], v[132:135], v[16:19]
    v_mfma_f32_16x16x32_bf16 v[4:7], v[72:75], v[136:139], v[4:7]
    v_mfma_f32_16x16x32_bf16 v[8:11], v[72:75], v[140:143], v[8:11]
    v_mfma_f32_16x16x32_bf16 v[12:15], v[72:75], v[144:147], v[12:15]
    v_mfma_f32_16x16x32_bf16 v[16:19], v[72:75], v[148:151], v[16:19]
    v_mfma_f32_16x16x32_bf16 v[4:7], v[76:79], v[152:155], v[4:7]
    v_mfma_f32_16x16x32_bf16 v[8:11], v[76:79], v[156:159], v[8:11]
    v_mfma_f32_16x16x32_bf16 v[12:15], v[76:79], v[160:163], v[12:15]
    v_mfma_f32_16x16x32_bf16 v[16:19], v[76:79], v[164:167], v[16:19]
    s_bitset1_b32 s55, 1
    s_nop 3
    v_pk_add_f32 v[4:5], v[4:5], v[6:7]
    v_pk_add_f32 v[8:9], v[8:9], v[10:11]
    v_pk_add_f32 v[12:13], v[12:13], v[14:15]
    v_pk_add_f32 v[16:17], v[16:17], v[18:19]
    v_add_f32 v84, v4, v5
    v_add_f32 v85, v8, v9
    v_add_f32 v86, v12, v13
    v_add_f32 v87, v16, v17
L_wgc_139:
    s_sub_u32 s72, s72, 1
    s_cmp_eq_u32 s55, 3
    s_cbranch_scc1 L_wgd
    s_branch L_wg
L_wgd:
    v_pk_add_f32 v[80:81], v[80:81], v[84:85]
    v_pk_add_f32 v[82:83], v[82:83], v[86:87]
    ds_write_b128 v37, v[80:83]
    s_lshl_b32 s74, s69, 2
    s_add_u32 s74, s74, 140544
    v_mov_b32 v20, s74
    v_mov_b32 v21, 1
    s_mov_b64 exec, 1
    ds_write_b32 v20, v21
    s_mov_b64 exec, -1
    s_cmp_lg_u32 s69, 0
    s_cbranch_scc1 L_fin
    v_mov_b32 v24, 140544
    s_mov_b32 s72, 64000000
L_lw_140:
    ds_read_b128 v[20:23], v24
    s_waitcnt lgkmcnt(0)
    v_and_b32 v20, v20, v22
    v_and_b32 v21, v21, v23
    v_and_b32 v20, v20, v21
    v_cmp_ne_u32 vcc, 1, v20
    s_nop 0
    s_cbranch_vccz L_lwdone_141
    s_sub_u32 s72, s72, 1
    s_cmp_lg_u32 s72, 0
    s_cbranch_scc1 L_lw_140
L_lwdone_141:
    ds_read_b128 v[4:7], v38 offset:0
    ds_read_b128 v[8:11], v38 offset:1024
    ds_read_b128 v[12:15], v38 offset:2048
    ds_read_b128 v[16:19], v38 offset:3072
    s_waitcnt lgkmcnt(2)
    v_pk_add_f32 v[4:5], v[4:5], v[8:9]
    v_pk_add_f32 v[6:7], v[6:7], v[10:11]
    s_waitcnt lgkmcnt(0)
    v_pk_add_f32 v[12:13], v[12:13], v[16:17]
    v_pk_add_f32 v[14:15], v[14:15], v[18:19]
    v_pk_add_f32 v[4:5], v[4:5], v[12:13]
    v_pk_add_f32 v[6:7], v[6:7], v[14:15]
    buffer_store_dwordx4 v[4:7], v42, s[40:43], s73 offen sc1
    s_branch L_fin
L_h_f:
    s_mov_b32 s32, s16
    s_mov_b32 s33, s17
    s_mov_b32 s34, 1835008
    s_mov_b32 s35, 0x20000
    s_mov_b32 s44, s20
    s_mov_b32 s45, s21
    s_mov_b32 s46, 1835008
    s_mov_b32 s47, 0x20000
    s_mul_i32 s73, s69, 458752
    s_lshl_b32 s74, s64, 6
    s_add_u32 s73, s73, s74
    v_mul_u32_u24 v3, 28672, v2
    v_and_b32 v4, 7, v0
    v_lshl_add_u32 v3, v4, 3, v3
    v_add_u32 v3, s73, v3
    s_mov_b32 exec_lo, 0xff00ff
    s_mov_b32 exec_hi, 0xff00ff
    s_mov_b32 s74, 0
    buffer_load_dwordx2 v[40:41], v3, s[32:35], s74 offen nt
    s_mov_b32 s74, 3584
    buffer_load_dwordx2 v[42:43], v3, s[32:35], s74 offen nt
    s_mov_b32 s74, 7168
    buffer_load_dwordx2 v[44:45], v3, s[32:35], s74 offen nt
    s_mov_b32 s74, 10752
    buffer_load_dwordx2 v[46:47], v3, s[32:35], s74 offen nt
    s_mov_b32 s74, 14336
    buffer_load_dwordx2 v[48:49], v3, s[32:35], s74 offen nt
    s_mov_b32 s74, 17920
    buffer_load_dwordx2 v[50:51], v3, s[32:35], s74 offen nt
    s_barrier
    s_mov_b32 s74, 21504
    buffer_load_dwordx2 v[52:53], v3, s[32:35], s74 offen nt
    s_mov_b32 s74, 25088
    buffer_load_dwordx2 v[54:55], v3, s[32:35], s74 offen nt
    s_mov_b32 s74, 114688
    buffer_load_dwordx2 v[56:57], v3, s[32:35], s74 offen nt
    s_mov_b32 s74, 118272
    buffer_load_dwordx2 v[58:59], v3, s[32:35], s74 offen nt
    s_mov_b32 s74, 121856
    buffer_load_dwordx2 v[60:61], v3, s[32:35], s74 offen nt
    s_mov_b32 s74, 125440
    buffer_load_dwordx2 v[62:63], v3, s[32:35], s74 offen nt
    s_mov_b32 s74, 129024
    buffer_load_dwordx2 v[64:65], v3, s[32:35], s74 offen nt
    s_mov_b32 s74, 132608
    buffer_load_dwordx2 v[66:67], v3, s[32:35], s74 offen nt
    s_mov_b32 s74, 136192
    buffer_load_dwordx2 v[68:69], v3, s[32:35], s74 offen nt
    s_mov_b32 s74, 139776
    buffer_load_dwordx2 v[70:71], v3, s[32:35], s74 offen nt
    s_mov_b32 s74, 229376
    buffer_load_dwordx2 v[72:73], v3, s[32:35], s74 offen nt
    s_mov_b32 s74, 232960
    buffer_load_dwordx2 v[74:75], v3, s[32:35], s74 offen nt
    s_mov_b32 s74, 236544
    buffer_load_dwordx2 v[76:77], v3, s[32:35], s74 offen nt
    s_mov_b32 s74, 240128
    buffer_load_dwordx2 v[78:79], v3, s[32:35], s74 offen nt
    s_mov_b32 s74, 243712
    buffer_load_dwordx2 v[80:81], v3, s[32:35], s74 offen nt
    s_mov_b32 s74, 247296
    buffer_load_dwordx2 v[82:83], v3, s[32:35], s74 offen nt
    s_mov_b32 s74, 250880
    buffer_load_dwordx2 v[84:85], v3, s[32:35], s74 offen nt
    s_mov_b32 s74, 254464
    buffer_load_dwordx2 v[86:87], v3, s[32:35], s74 offen nt
    s_mov_b32 s74, 344064
    buffer_load_dwordx2 v[88:89], v3, s[32:35], s74 offen nt
    s_mov_b32 s74, 347648
    buffer_load_dwordx2 v[90:91], v3, s[32:35], s74 offen nt
    s_mov_b32 s74, 351232
    buffer_load_dwordx2 v[92:93], v3, s[32:35], s74 offen nt
    s_mov_b32 s74, 354816
    buffer_load_dwordx2 v[94:95], v3, s[32:35], s74 offen nt
    s_mov_b32 s74, 358400
    buffer_load_dwordx2 v[96:97], v3, s[32:35], s74 offen nt
    s_mov_b32 s74, 361984
    buffer_load_dwordx2 v[98:99], v3, s[32:35], s74 offen nt
    s_mov_b32 s74, 365568
    buffer_load_dwordx2 v[100:101], v3, s[32:35], s74 offen nt
    s_waitcnt lgkmcnt(0)
    s_add_u32 s63, s63, 2654435769
    s_mov_b32 s74, 369152
    buffer_load_dwordx2 v[102:103], v3, s[32:35], s74 offen nt
    s_mov_b64 exec, -1
    s_cmp_eq_u32 s69, 0
    s_cbranch_scc1 L_h_common
    s_lshl_b32 s74, s69, 11
    s_add_u32 s52, s74, 18432
    s_add_u32 s53, s74, 26624
    s_add_u32 s54, s74, 34816
    s_add_u32 s55, s74, 43008
    v_lshlrev_b32 v34, 4, v0
    s_lshl_b32 s74, s69, 12
    s_add_u32 s74, s74, 138112
    v_lshl_add_u32 v35, v0, 3, s74
    v_mov_b32 v5, 140564
    s_mov_b32 s72, 64000000
L_lw_142:
    ds_read_b32 v6, v5
    s_waitcnt lgkmcnt(0)
    v_cmp_ne_u32 vcc, 1, v6
    s_nop 0
    s_cbranch_vccz L_lwdone_143
    s_sleep 4
    s_sub_u32 s72, s72, 1
    s_cmp_lg_u32 s72, 0
    s_cbranch_scc1 L_lw_142
L_lwdone_143:
    s_cmp_lg_u32 s69, 1
    s_cbranch_scc1 L_nox
    s_mov_b32 s44, s4
    s_mov_b32 s45, s5
    s_mov_b32 s46, 4096
    s_mov_b32 s47, 0x20000
    buffer_load_dwordx4 v[8:11], v34, s[44:47], 0 offen offset:0
    buffer_load_dwordx4 v[12:15], v34, s[44:47], 0 offen offset:1024
    buffer_load_dwordx4 v[16:19], v34, s[44:47], 0 offen offset:2048
    buffer_load_dwordx4 v[20:23], v34, s[44:47], 0 offen offset:3072
    v_add_u32 v33, 154496, v34
    s_waitcnt vmcnt(0)
    ds_write_b128 v33, v[8:11] offset:0
    ds_write_b128 v33, v[12:15] offset:1024
    ds_write_b128 v33, v[16:19] offset:2048
    ds_write_b128 v33, v[20:23] offset:3072
L_nox:
    s_mov_b32 s72, 1000000
L_pp_144:
    buffer_load_dwordx4 v[104:107], v34, s[40:43], s52 offen offset:0 sc1
    buffer_load_dwordx4 v[108:111], v34, s[40:43], s52 offen offset:1024 sc1
    buffer_load_dwordx4 v[112:115], v34, s[40:43], s53 offen offset:0 sc1
    buffer_load_dwordx4 v[116:119], v34, s[40:43], s53 offen offset:1024 sc1
    buffer_load_dwordx4 v[120:123], v34, s[40:43], s54 offen offset:0 sc1
    buffer_load_dwordx4 v[124:127], v34, s[40:43], s54 offen offset:1024 sc1
    buffer_load_dwordx4 v[128:131], v34, s[40:43], s55 offen offset:0 sc1
    buffer_load_dwordx4 v[132:135], v34, s[40:43], s55 offen offset:1024 sc1
    s_waitcnt vmcnt(0)
    v_cmp_ne_u32 s[76:77], s63, v105
    v_cmp_ne_u32 vcc, s63, v107
    s_nop 0
    s_or_b64 s[76:77], s[76:77], vcc
    v_cmp_ne_u32 vcc, s63, v109
    s_nop 0
    s_or_b64 s[76:77], s[76:77], vcc
    v_cmp_ne_u32 vcc, s63, v111
    s_nop 0
    s_or_b64 s[76:77], s[76:77], vcc
    v_cmp_ne_u32 vcc, s63, v113
    s_nop 0
    s_or_b64 s[76:77], s[76:77], vcc
    v_cmp_ne_u32 vcc, s63, v115
    s_nop 0
    s_or_b64 s[76:77], s[76:77], vcc
    v_cmp_ne_u32 vcc, s63, v117
    s_nop 0
    s_or_b64 s[76:77], s[76:77], vcc
    v_cmp_ne_u32 vcc, s63, v119
    s_nop 0
    s_or_b64 s[76:77], s[76:77], vcc
    v_cmp_ne_u32 vcc, s63, v121
    s_nop 0
    s_or_b64 s[76:77], s[76:77], vcc
    v_cmp_ne_u32 vcc, s63, v123
    s_nop 0
    s_or_b64 s[76:77], s[76:77], vcc
    v_cmp_ne_u32 vcc, s63, v125
    s_nop 0
    s_or_b64 s[76:77], s[76:77], vcc
    v_cmp_ne_u32 vcc, s63, v127
    s_nop 0
    s_or_b64 s[76:77], s[76:77], vcc
    v_cmp_ne_u32 vcc, s63, v129
    s_nop 0
    s_or_b64 s[76:77], s[76:77], vcc
    v_cmp_ne_u32 vcc, s63, v131
    s_nop 0
    s_or_b64 s[76:77], s[76:77], vcc
    v_cmp_ne_u32 vcc, s63, v133
    s_nop 0
    s_or_b64 s[76:77], s[76:77], vcc
    v_cmp_ne_u32 vcc, s63, v135
    s_nop 0
    s_or_b64 s[76:77], s[76:77], vcc
    s_cmp_eq_u64 s[76:77], 0
    s_cbranch_scc1 L_ppdone_146
    s_sleep 8
    s_sub_u32 s72, s72, 1
    s_cmp_lg_u32 s72, 0
    s_cbranch_scc1 L_pp_144
L_ppdone_146:
    s_cmp_lg_u32 s69, 3
    s_cbranch_scc1 L_noc1
    v_lshlrev_b32 v105, 16, v104
    v_and_b32 v104, 0xffff0000, v104
    v_add_f32 v105, 1.0, v105
    v_add_f32 v104, 1.0, v104
    v_cvt_pk_bf16_f32 v104, v105, v104
    v_lshlrev_b32 v107, 16, v106
    v_and_b32 v106, 0xffff0000, v106
    v_add_f32 v107, 1.0, v107
    v_add_f32 v106, 1.0, v106
    v_cvt_pk_bf16_f32 v106, v107, v106
    v_lshlrev_b32 v109, 16, v108
    v_and_b32 v108, 0xffff0000, v108
    v_add_f32 v109, 1.0, v109
    v_add_f32 v108, 1.0, v108
    v_cvt_pk_bf16_f32 v108, v109, v108
    v_lshlrev_b32 v111, 16, v110
    v_and_b32 v110, 0xffff0000, v110
    v_add_f32 v111, 1.0, v111
    v_add_f32 v110, 1.0, v110
    v_cvt_pk_bf16_f32 v110, v111, v110
    v_lshlrev_b32 v113, 16, v112
    v_and_b32 v112, 0xffff0000, v112
    v_add_f32 v113, 1.0, v113
    v_add_f32 v112, 1.0, v112
    v_cvt_pk_bf16_f32 v112, v113, v112
    v_lshlrev_b32 v115, 16, v114
    v_and_b32 v114, 0xffff0000, v114
    v_add_f32 v115, 1.0, v115
    v_add_f32 v114, 1.0, v114
    v_cvt_pk_bf16_f32 v114, v115, v114
    v_lshlrev_b32 v117, 16, v116
    v_and_b32 v116, 0xffff0000, v116
    v_add_f32 v117, 1.0, v117
    v_add_f32 v116, 1.0, v116
    v_cvt_pk_bf16_f32 v116, v117, v116
    v_lshlrev_b32 v119, 16, v118
    v_and_b32 v118, 0xffff0000, v118
    v_add_f32 v119, 1.0, v119
    v_add_f32 v118, 1.0, v118
    v_cvt_pk_bf16_f32 v118, v119, v118
    v_lshlrev_b32 v121, 16, v120
    v_and_b32 v120, 0xffff0000, v120
    v_add_f32 v121, 1.0, v121
    v_add_f32 v120, 1.0, v120
    v_cvt_pk_bf16_f32 v120, v121, v120
    v_lshlrev_b32 v123, 16, v122
    v_and_b32 v122, 0xffff0000, v122
    v_add_f32 v123, 1.0, v123
    v_add_f32 v122, 1.0, v122
    v_cvt_pk_bf16_f32 v122, v123, v122
    v_lshlrev_b32 v125, 16, v124
    v_and_b32 v124, 0xffff0000, v124
    v_add_f32 v125, 1.0, v125
    v_add_f32 v124, 1.0, v124
    v_cvt_pk_bf16_f32 v124, v125, v124
    v_lshlrev_b32 v127, 16, v126
    v_and_b32 v126, 0xffff0000, v126
    v_add_f32 v127, 1.0, v127
    v_add_f32 v126, 1.0, v126
    v_cvt_pk_bf16_f32 v126, v127, v126
    v_lshlrev_b32 v129, 16, v128
    v_and_b32 v128, 0xffff0000, v128
    v_add_f32 v129, 1.0, v129
    v_add_f32 v128, 1.0, v128
    v_cvt_pk_bf16_f32 v128, v129, v128
    v_lshlrev_b32 v131, 16, v130
    v_and_b32 v130, 0xffff0000, v130
    v_add_f32 v131, 1.0, v131
    v_add_f32 v130, 1.0, v130
    v_cvt_pk_bf16_f32 v130, v131, v130
    v_lshlrev_b32 v133, 16, v132
    v_and_b32 v132, 0xffff0000, v132
    v_add_f32 v133, 1.0, v133
    v_add_f32 v132, 1.0, v132
    v_cvt_pk_bf16_f32 v132, v133, v132
    v_lshlrev_b32 v135, 16, v134
    v_and_b32 v134, 0xffff0000, v134
    v_add_f32 v135, 1.0, v135
    v_add_f32 v134, 1.0, v134
    v_cvt_pk_bf16_f32 v134, v135, v134
L_noc1:
    v_mov_b32 v105, v106
    ds_write_b64 v35, v[104:105] offset:0
    v_mov_b32 v109, v110
    ds_write_b64 v35, v[108:109] offset:512
    v_mov_b32 v113, v114
    ds_write_b64 v35, v[112:113] offset:1024
    v_mov_b32 v117, v118
    ds_write_b64 v35, v[116:117] offset:1536
    v_mov_b32 v121, v122
    ds_write_b64 v35, v[120:121] offset:2048
    v_mov_b32 v125, v126
    ds_write_b64 v35, v[124:125] offset:2560
    v_mov_b32 v129, v130
    ds_write_b64 v35, v[128:129] offset:3072
    v_mov_b32 v133, v134
    ds_write_b64 v35, v[132:133] offset:3584
L_ppend_145:
    v_mov_b32 v5, 140592
    v_mov_b32 v6, 1
    s_mov_b64 exec, 1
    ds_add_u32 v5, v6
    s_mov_b64 exec, -1
    s_cmp_lg_u32 s69, 2
    s_cbranch_scc1 L_notch
    v_mov_b32 v8, 0
    s_mov_b64 exec, 1
    s_mov_b32 s44, s18
    s_mov_b32 s45, s19
    s_mov_b32 s46, 1835008
    s_mov_b32 s47, 0x20000
    buffer_load_dword v10, v8, s[44:47], 0 offen nt
    s_mov_b32 s44, s20
    s_mov_b32 s45, s21
    s_mov_b32 s46, 1835008
    s_mov_b32 s47, 0x20000
    s_lshl_b32 s73, s64, 15
    buffer_load_dword v11, v8, s[44:47], s73 offen nt
    s_mov_b64 exec, -1
    s_waitcnt vmcnt(0)
L_notch:
    s_cmp_lg_u32 s69, 3
    s_cbranch_scc1 L_h_f2
    v_mov_b32 v5, 140596
    s_mov_b32 s72, 64000000
L_lw_147:
    ds_read_b32 v6, v5
    s_waitcnt lgkmcnt(0)
    v_cmp_ne_u32 vcc, 1, v6
    s_nop 0
    s_cbranch_vccz L_lwdone_148
    s_sleep 4
    s_sub_u32 s72, s72, 1
    s_cmp_lg_u32 s72, 0
    s_cbranch_scc1 L_lw_147
L_lwdone_148:
    s_getpc_b64 s[76:77]
L_pc_149:
    s_add_u32 s76, s76, L_kpost_f-L_pc_149
    s_addc_u32 s77, s77, (L_kpost_f-L_pc_149)>>32
    v_lshlrev_b32 v8, 7, v0
    v_cmp_gt_u32 vcc, L_h_q-L_kpost_f, v8
    s_nop 1
    v_cndmask_b32 v8, 0, v8, vcc
    global_load_dword v9, v8, s[76:77]
    s_getpc_b64 s[76:77]
L_pc_150:
    s_add_u32 s76, s76, L_h_f2-L_pc_150
    s_addc_u32 s77, s77, (L_h_f2-L_pc_150)>>32
    v_lshlrev_b32 v10, 7, v0
    v_cmp_gt_u32 vcc, L_fin-L_h_f2, v10
    s_nop 1
    v_cndmask_b32 v10, 0, v10, vcc
    global_load_dword v11, v10, s[76:77]
    s_waitcnt vmcnt(0)
L_h_f2:
    v_mov_b32 v5, 140580
    s_mov_b32 s72, 64000000
L_lw_151:
    ds_read_b32 v6, v5
    s_waitcnt lgkmcnt(0)
    v_cmp_ne_u32 vcc, 8, v6
    s_nop 0
    s_cbranch_vccz L_lwdone_152
    s_sleep 2
    s_sub_u32 s72, s72, 1
    s_cmp_lg_u32 s72, 0
    s_cbranch_scc1 L_lw_151
L_lwdone_152:
    s_setprio 2
L_h_f3:
    s_mov_b32 s32, s18
    s_mov_b32 s33, s19
    s_mov_b32 s34, 1835008
    s_mov_b32 s35, 0x20000
    s_mov_b32 s44, s20
    s_mov_b32 s45, s21
    s_mov_b32 s46, 1835008
    s_mov_b32 s47, 0x20000
    s_mul_i32 s73, s69, 458752
    s_lshl_b32 s74, s64, 6
    s_add_u32 s73, s73, s74
    v_mul_u32_u24 v3, 28672, v2
    v_and_b32 v4, 7, v0
    v_lshl_add_u32 v3, v4, 3, v3
    v_add_u32 v3, s73, v3
    v_lshrrev_b32 v37, 2, v0
    v_mul_u32_u24 v37, 3584, v37
    v_and_b32 v38, 3, v0
    v_lshl_add_u32 v37, v38, 4, v37
    v_add_u32 v37, s73, v37
    s_lshl_b32 s52, s69, 14
    s_add_u32 s52, s52, 69632
    s_lshl_b32 s54, s64, 15
    s_lshl_b32 s74, s69, 8
    s_add_u32 s54, s54, s74
    s_add_u32 s55, s54, 4096
    v_lshlrev_b32 v36, 13, v2
    v_lshl_add_u32 v36, v1, 4, v36
    s_add_u32 s53, s52, 0
    s_mov_b32 m0, s53
    s_mov_b32 s74, 0
    buffer_load_dwordx4 v37, s[32:35], s74 offen nt lds
    buffer_load_dwordx4 v[4:7], v36, s[44:47], s54 offen offset:0 nt
    s_add_u32 s53, s52, 1024
    s_mov_b32 m0, s53
    s_mov_b32 s74, 57344
    buffer_load_dwordx4 v37, s[32:35], s74 offen nt lds
    buffer_load_dwordx4 v[8:11], v36, s[44:47], s54 offen offset:1024 nt
    v_mov_b32 v38, 140572
    s_mov_b32 s72, 64000000
L_lw_153:
    ds_read_b32 v39, v38
    s_waitcnt lgkmcnt(0)
    v_cmp_ne_u32 vcc, 2, v39
    s_nop 0
    s_cbranch_vccz L_lwdone_154
    s_sleep 1
    s_sub_u32 s72, s72, 1
    s_cmp_lg_u32 s72, 0
    s_cbranch_scc1 L_lw_153
L_lwdone_154:
    s_add_u32 s53, s52, 2048
    s_mov_b32 m0, s53
    s_mov_b32 s74, 114688
    buffer_load_dwordx4 v37, s[32:35], s74 offen nt lds
    buffer_load_dwordx4 v[12:15], v36, s[44:47], s54 offen offset:2048 nt
    s_add_u32 s53, s52, 3072
    s_mov_b32 m0, s53
    s_mov_b32 s74, 172032
    buffer_load_dwordx4 v37, s[32:35], s74 offen nt lds
    buffer_load_dwordx4 v[16:19], v36, s[44:47], s54 offen offset:3072 nt
    s_add_u32 s53, s52, 4096
    s_mov_b32 m0, s53
    s_mov_b32 s74, 229376
    buffer_load_dwordx4 v37, s[32:35], s74 offen nt lds
    buffer_load_dwordx4 v[20:23], v36, s[44:47], s55 offen offset:0 nt
    s_add_u32 s53, s52, 5120
    s_mov_b32 m0, s53
    s_mov_b32 s74, 286720
    buffer_load_dwordx4 v37, s[32:35], s74 offen nt lds
    buffer_load_dwordx4 v[24:27], v36, s[44:47], s55 offen offset:1024 nt
    s_add_u32 s53, s52, 6144
    s_mov_b32 m0, s53
    s_mov_b32 s74, 344064
    buffer_load_dwordx4 v37, s[32:35], s74 offen nt lds
    buffer_load_dwordx4 v[28:31], v36, s[44:47], s55 offen offset:2048 nt
    s_add_u32 s53, s52, 7168
    s_mov_b32 m0, s53
    s_mov_b32 s74, 401408
    buffer_load_dwordx4 v37, s[32:35], s74 offen nt lds
    buffer_load_dwordx4 v[32:35], v36, s[44:47], s55 offen offset:3072 nt
    v_mov_b32 v38, 140588
    v_mov_b32 v39, 1
    s_mov_b64 exec, 1
    ds_add_u32 v38, v39
    s_mov_b64 exec, -1
    v_and_b32 v38, 7, v0
    v_lshlrev_b32 v38, 3, v38
    v_lshl_add_u32 v38, v2, 9, v38
    v_add_u32 v38, s52, v38
    s_waitcnt vmcnt(13)
    s_mov_b32 exec_lo, 0xff00ff00
    s_mov_b32 exec_hi, 0xff00ff00
    ds_read_b64 v[40:41], v38 offset:0
    ds_read_b64 v[42:43], v38 offset:64
    ds_read_b64 v[44:45], v38 offset:128
    ds_read_b64 v[46:47], v38 offset:192
    ds_read_b64 v[48:49], v38 offset:256
    ds_read_b64 v[50:51], v38 offset:320
    ds_read_b64 v[52:53], v38 offset:384
    ds_read_b64 v[54:55], v38 offset:448
    s_mov_b64 exec, -1
    s_waitcnt vmcnt(12)
    v_perm_b32 v136, v8, v4, s70
    v_perm_b32 v140, v8, v4, s71
    v_perm_b32 v144, v9, v5, s70
    v_perm_b32 v148, v9, v5, s71
    v_perm_b32 v152, v10, v6, s70
    v_perm_b32 v156, v10, v6, s71
    v_perm_b32 v160, v11, v7, s70
    v_perm_b32 v164, v11, v7, s71
    s_waitcnt lgkmcnt(0)
    v_perm_b32 v104, v42, v40, s70
    v_perm_b32 v105, v46, v44, s70
    v_perm_b32 v106, v50, v48, s70
    v_perm_b32 v107, v54, v52, s70
    v_perm_b32 v108, v42, v40, s71
    v_perm_b32 v109, v46, v44, s71
    v_perm_b32 v110, v50, v48, s71
    v_perm_b32 v111, v54, v52, s71
    v_perm_b32 v112, v43, v41, s70
    v_perm_b32 v113, v47, v45, s70
    v_perm_b32 v114, v51, v49, s70
    v_perm_b32 v115, v55, v53, s70
    v_perm_b32 v116, v43, v41, s71
    v_perm_b32 v117, v47, v45, s71
    v_perm_b32 v118, v51, v49, s71
    v_perm_b32 v119, v55, v53, s71
    s_waitcnt vmcnt(9)
    s_mov_b32 exec_lo, 0xff00ff00
    s_mov_b32 exec_hi, 0xff00ff00
    ds_read_b64 v[56:57], v38 offset:2048
    ds_read_b64 v[58:59], v38 offset:2112
    ds_read_b64 v[60:61], v38 offset:2176
    ds_read_b64 v[62:63], v38 offset:2240
    ds_read_b64 v[64:65], v38 offset:2304
    ds_read_b64 v[66:67], v38 offset:2368
    ds_read_b64 v[68:69], v38 offset:2432
    ds_read_b64 v[70:71], v38 offset:2496
    s_mov_b64 exec, -1
    s_waitcnt vmcnt(8)
    v_perm_b32 v137, v16, v12, s70
    v_perm_b32 v141, v16, v12, s71
    v_perm_b32 v145, v17, v13, s70
    v_perm_b32 v149, v17, v13, s71
    v_perm_b32 v153, v18, v14, s70
    v_perm_b32 v157, v18, v14, s71
    v_perm_b32 v161, v19, v15, s70
    v_perm_b32 v165, v19, v15, s71
    s_waitcnt lgkmcnt(0)
    v_perm_b32 v120, v58, v56, s70
    v_perm_b32 v121, v62, v60, s70
    v_perm_b32 v122, v66, v64, s70
    v_perm_b32 v123, v70, v68, s70
    v_perm_b32 v124, v58, v56, s71
    v_perm_b32 v125, v62, v60, s71
    v_perm_b32 v126, v66, v64, s71
    v_perm_b32 v127, v70, v68, s71
    v_perm_b32 v128, v59, v57, s70
    v_perm_b32 v129, v63, v61, s70
    v_perm_b32 v130, v67, v65, s70
    v_perm_b32 v131, v71, v69, s70
    v_perm_b32 v132, v59, v57, s71
    v_perm_b32 v133, v63, v61, s71
    v_perm_b32 v134, v67, v65, s71
    v_perm_b32 v135, v71, v69, s71
    s_waitcnt vmcnt(5)
    s_mov_b32 exec_lo, 0xff00ff00
    s_mov_b32 exec_hi, 0xff00ff00
    ds_read_b64 v[72:73], v38 offset:4096
    ds_read_b64 v[74:75], v38 offset:4160
    ds_read_b64 v[76:77], v38 offset:4224
    ds_read_b64 v[78:79], v38 offset:4288
    ds_read_b64 v[80:81], v38 offset:4352
    ds_read_b64 v[82:83], v38 offset:4416
    ds_read_b64 v[84:85], v38 offset:4480
    ds_read_b64 v[86:87], v38 offset:4544
    s_mov_b64 exec, -1
    s_waitcnt vmcnt(4)
    v_perm_b32 v138, v24, v20, s70
    v_perm_b32 v142, v24, v20, s71
    v_perm_b32 v146, v25, v21, s70
    v_perm_b32 v150, v25, v21, s71
    v_perm_b32 v154, v26, v22, s70
    v_perm_b32 v158, v26, v22, s71
    v_perm_b32 v162, v27, v23, s70
    v_perm_b32 v166, v27, v23, s71
    s_waitcnt lgkmcnt(0)
    v_perm_b32 v40, v74, v72, s70
    v_perm_b32 v41, v78, v76, s70
    v_perm_b32 v42, v82, v80, s70
    v_perm_b32 v43, v86, v84, s70
    v_perm_b32 v44, v74, v72, s71
    v_perm_b32 v45, v78, v76, s71
    v_perm_b32 v46, v82, v80, s71
    v_perm_b32 v47, v86, v84, s71
    v_perm_b32 v48, v75, v73, s70
    v_perm_b32 v49, v79, v77, s70
    v_perm_b32 v50, v83, v81, s70
    v_perm_b32 v51, v87, v85, s70
    v_perm_b32 v52, v75, v73, s71
    v_perm_b32 v53, v79, v77, s71
    v_perm_b32 v54, v83, v81, s71
    v_perm_b32 v55, v87, v85, s71
    s_waitcnt vmcnt(1)
    s_mov_b32 exec_lo, 0xff00ff00
    s_mov_b32 exec_hi, 0xff00ff00
    ds_read_b64 v[88:89], v38 offset:6144
    ds_read_b64 v[90:91], v38 offset:6208
    ds_read_b64 v[92:93], v38 offset:6272
    ds_read_b64 v[94:95], v38 offset:6336
    ds_read_b64 v[96:97], v38 offset:6400
    ds_read_b64 v[98:99], v38 offset:6464
    ds_read_b64 v[100:101], v38 offset:6528
    ds_read_b64 v[102:103], v38 offset:6592
    s_mov_b64 exec, -1
    s_waitcnt vmcnt(0)
    v_perm_b32 v139, v32, v28, s70
    v_perm_b32 v143, v32, v28, s71
    v_perm_b32 v147, v33, v29, s70
    v_perm_b32 v151, v33, v29, s71
    v_perm_b32 v155, v34, v30, s70
    v_perm_b32 v159, v34, v30, s71
    v_perm_b32 v163, v35, v31, s70
    v_perm_b32 v167, v35, v31, s71
    s_waitcnt lgkmcnt(0)
    v_perm_b32 v56, v90, v88, s70
    v_perm_b32 v57, v94, v92, s70
    v_perm_b32 v58, v98, v96, s70
    v_perm_b32 v59, v102, v100, s70
    v_perm_b32 v60, v90, v88, s71
    v_perm_b32 v61, v94, v92, s71
    v_perm_b32 v62, v98, v96, s71
    v_perm_b32 v63, v102, v100, s71
    v_perm_b32 v64, v91, v89, s70
    v_perm_b32 v65, v95, v93, s70
    v_perm_b32 v66, v99, v97, s70
    v_perm_b32 v67, v103, v101, s70
    v_perm_b32 v68, v91, v89, s71
    v_perm_b32 v69, v95, v93, s71
    v_perm_b32 v70, v99, v97, s71
    v_perm_b32 v71, v103, v101, s71
L_f_loaded:
L_hpost_f:
    s_setprio 3
    v_and_b32 v36, 3, v0
    v_mul_u32_u24 v36, 1088, v36
    v_lshl_add_u32 v36, v2, 4, v36
    s_lshl_b32 s74, s69, 8
    s_add_u32 s74, s74, 132096
    v_add_u32 v36, s74, v36
    v_lshlrev_b32 v38, 4, v0
    v_add_u32 v38, 136448, v38
    s_lshl_b32 s74, s69, 10
    v_add_u32 v37, s74, v38
    v_lshlrev_b32 v39, 6, v1
    v_lshl_add_u32 v39, v2, 4, v39
    v_mov_b32 v72, 0
    v_mov_b32 v73, 0
    v_mov_b32 v74, 0
    v_mov_b32 v75, 0
    v_mov_b32 v76, 0
    v_mov_b32 v77, 0
    v_mov_b32 v78, 0
    v_mov_b32 v79, 0
    v_mov_b32 v80, 0
    v_mov_b32 v81, 0
    v_mov_b32 v82, 0
    v_mov_b32 v83, 0
    v_mov_b32 v84, 0
    v_mov_b32 v85, 0
    v_mov_b32 v86, 0
    v_mov_b32 v87, 0
    v_mov_b32 v92, 0xc0135761
    s_mov_b32 s75, 0xbdd2d3e8
    s_lshl_b32 s74, s69, 8
    s_add_u32 s74, s74, 141184
    v_lshlrev_b32 v88, 3, v1
    v_lshl_add_u32 v88, v2, 1, v88
    v_add_u32 v88, s74, v88
    v_and_b32 v89, 3, v0
    v_lshlrev_b32 v89, 6, v89
    v_lshl_add_u32 v89, v2, 4, v89
    v_add_u32 v89, s74, v89
    s_lshl_b32 s73, s64, 13
    s_lshl_b32 s74, s69, 11
    s_add_u32 s73, s73, s74
    s_add_u32 s73, s73, 851968
    v_lshlrev_b32 v90, 6, v1
    v_lshl_add_u32 v90, v2, 4, v90
    v_mov_b32 v4, 140592
    s_mov_b32 s72, 64000000
L_lw_155:
    ds_read_b32 v5, v4
    s_waitcnt lgkmcnt(0)
    v_cmp_ne_u32 vcc, 3, v5
    s_nop 0
    s_cbranch_vccz L_lwdone_156
    s_sleep 1
    s_sub_u32 s72, s72, 1
    s_cmp_lg_u32 s72, 0
    s_cbranch_scc1 L_lw_155
L_lwdone_156:
    v_and_b32 v93, 3, v0
    v_lshlrev_b32 v93, 10, v93
    v_bfe_u32 v94, v0, 2, 1
    v_lshlrev_b32 v94, 12, v94
    v_sub_u32 v93, v93, v94
    v_lshl_add_u32 v93, v2, 4, v93
    s_lshl_b32 s74, s69, 8
    s_add_u32 s74, s74, 150400
    v_add_u32 v93, s74, v93
    ds_read_b128 v[20:23], v93 offset:0
    ds_read_b128 v[24:27], v93 offset:64
    ds_read_b128 v[28:31], v93 offset:128
    ds_read_b128 v[32:35], v93 offset:192
    s_lshl_b32 s74, s69, 11
    s_add_u32 s74, s74, 34816
    v_lshl_add_u32 v94, v0, 4, s74
    v_lshlrev_b32 v95, 9, v2
    v_lshl_add_u32 v95, v1, 4, v95
    v_add_u32 v95, 34816, v95
    v_mov_b32 v91, 140640
    s_waitcnt lgkmcnt(3)
    v_mfma_f32_16x16x32_bf16 v[4:7], v[20:23], v[104:107], 0
    v_mfma_f32_16x16x32_bf16 v[8:11], v[20:23], v[108:111], 0
    v_mfma_f32_16x16x32_bf16 v[12:15], v[20:23], v[112:115], 0
    v_mfma_f32_16x16x32_bf16 v[16:19], v[20:23], v[116:119], 0
    s_waitcnt lgkmcnt(2)
    v_mfma_f32_16x16x32_bf16 v[4:7], v[24:27], v[120:123], v[4:7]
    v_mfma_f32_16x16x32_bf16 v[8:11], v[24:27], v[124:127], v[8:11]
    v_mfma_f32_16x16x32_bf16 v[12:15], v[24:27], v[128:131], v[12:15]
    v_mfma_f32_16x16x32_bf16 v[16:19], v[24:27], v[132:135], v[16:19]
    s_waitcnt lgkmcnt(1)
    v_mfma_f32_16x16x32_bf16 v[4:7], v[28:31], v[40:43], v[4:7]
    v_mfma_f32_16x16x32_bf16 v[8:11], v[28:31], v[44:47], v[8:11]
    v_mfma_f32_16x16x32_bf16 v[12:15], v[28:31], v[48:51], v[12:15]
    v_mfma_f32_16x16x32_bf16 v[16:19], v[28:31], v[52:55], v[16:19]
    s_waitcnt lgkmcnt(0)
    v_mfma_f32_16x16x32_bf16 v[4:7], v[32:35], v[56:59], v[4:7]
    v_mfma_f32_16x16x32_bf16 v[8:11], v[32:35], v[60:63], v[8:11]
    v_mfma_f32_16x16x32_bf16 v[12:15], v[32:35], v[64:67], v[12:15]
    v_mfma_f32_16x16x32_bf16 v[16:19], v[32:35], v[68:71], v[16:19]
    s_mov_b32 exec_hi, 0
    s_nop 3
    ds_write_b128 v94, v[4:7] offset:0
    ds_write_b128 v94, v[8:11] offset:512
    ds_write_b128 v94, v[12:15] offset:1024
    ds_write_b128 v94, v[16:19] offset:1536
    s_mov_b64 exec, -1
    s_lshl_b32 s74, s69, 2
    s_add_u32 s74, s74, 140544
    v_mov_b32 v20, s74
    v_mov_b32 v21, 1
    s_mov_b64 exec, 1
    ds_write_b32 v20, v21
    s_mov_b64 exec, -1
    v_mov_b32 v24, 140544
    s_mov_b32 s72, 64000000
L_lw_157:
    ds_read_b128 v[20:23], v24
    s_waitcnt lgkmcnt(0)
    v_and_b32 v20, v20, v22
    v_and_b32 v21, v21, v23
    v_and_b32 v20, v20, v21
    v_cmp_ne_u32 vcc, 1, v20
    s_nop 0
    s_cbranch_vccz L_lwdone_158
    s_sub_u32 s72, s72, 1
    s_cmp_lg_u32 s72, 0
    s_cbranch_scc1 L_lw_157
L_lwdone_158:
    ds_read_b128 v[4:7], v95 offset:0
    ds_read_b128 v[8:11], v95 offset:2048
    ds_read_b128 v[12:15], v95 offset:4096
    ds_read_b128 v[16:19], v95 offset:6144
    ds_read_b128 v[20:23], v95 offset:256
    ds_read_b128 v[24:27], v95 offset:2304
    ds_read_b128 v[28:31], v95 offset:4352
    ds_read_b128 v[32:35], v95 offset:6400
    s_waitcnt lgkmcnt(0)
    v_pk_add_f32 v[4:5], v[4:5], v[8:9]
    v_pk_add_f32 v[6:7], v[6:7], v[10:11]
    v_pk_add_f32 v[12:13], v[12:13], v[16:17]
    v_pk_add_f32 v[14:15], v[14:15], v[18:19]
    v_pk_add_f32 v[96:97], v[4:5], v[12:13]
    v_pk_add_f32 v[98:99], v[6:7], v[14:15]
    v_pk_add_f32 v[20:21], v[20:21], v[24:25]
    v_pk_add_f32 v[22:23], v[22:23], v[26:27]
    v_pk_add_f32 v[28:29], v[28:29], v[32:33]
    v_pk_add_f32 v[30:31], v[30:31], v[34:35]
    v_pk_add_f32 v[100:101], v[20:21], v[28:29]
    v_pk_add_f32 v[102:103], v[22:23], v[30:31]
    s_barrier
    ds_read_b128 v[20:23], v36 offset:0
    ds_read_b128 v[24:27], v36 offset:64
    ds_read_b128 v[28:31], v36 offset:128
    ds_read_b128 v[32:35], v36 offset:192
    s_waitcnt lgkmcnt(3)
    v_mfma_f32_16x16x32_bf16 v[4:7], v[20:23], v[104:107], 0
    v_mfma_f32_16x16x32_bf16 v[8:11], v[20:23], v[108:111], 0
    v_mfma_f32_16x16x32_bf16 v[12:15], v[20:23], v[112:115], 0
    v_mfma_f32_16x16x32_bf16 v[16:19], v[20:23], v[116:119], 0
    s_waitcnt lgkmcnt(2)
    v_mfma_f32_16x16x32_bf16 v[4:7], v[24:27], v[120:123], v[4:7]
    v_mfma_f32_16x16x32_bf16 v[8:11], v[24:27], v[124:127], v[8:11]
    v_mfma_f32_16x16x32_bf16 v[12:15], v[24:27], v[128:131], v[12:15]
    v_mfma_f32_16x16x32_bf16 v[16:19], v[24:27], v[132:135], v[16:19]
    s_waitcnt lgkmcnt(1)
    v_mfma_f32_16x16x32_bf16 v[4:7], v[28:31], v[40:43], v[4:7]
    v_mfma_f32_16x16x32_bf16 v[8:11], v[28:31], v[44:47], v[8:11]
    v_mfma_f32_16x16x32_bf16 v[12:15], v[28:31], v[48:51], v[12:15]
    v_mfma_f32_16x16x32_bf16 v[16:19], v[28:31], v[52:55], v[16:19]
    s_waitcnt lgkmcnt(0)
    v_mfma_f32_16x16x32_bf16 v[4:7], v[32:35], v[56:59], v[4:7]
    v_mfma_f32_16x16x32_bf16 v[8:11], v[32:35], v[60:63], v[8:11]
    v_mfma_f32_16x16x32_bf16 v[12:15], v[32:35], v[64:67], v[12:15]
    v_mfma_f32_16x16x32_bf16 v[16:19], v[32:35], v[68:71], v[16:19]
    s_mov_b32 exec_lo, 0xffff
    s_mov_b32 exec_hi, 0x0
    s_nop 2
    ds_write_b128 v37, v[4:7] offset:0
    ds_write_b128 v37, v[8:11] offset:256
    ds_write_b128 v37, v[12:15] offset:512
    ds_write_b128 v37, v[16:19] offset:768
    s_mov_b64 exec, -1
    s_waitcnt lgkmcnt(0)
    s_barrier
    ds_read_b128 v[20:23], v91
    ds_read_b128 v[24:27], v91 offset:16
    ds_read_b128 v[4:7], v38 offset:0
    ds_read_b128 v[8:11], v38 offset:1024
    ds_read_b128 v[12:15], v38 offset:2048
    ds_read_b128 v[16:19], v38 offset:3072
    s_waitcnt lgkmcnt(2)
    v_pk_add_f32 v[4:5], v[4:5], v[8:9]
    v_pk_add_f32 v[6:7], v[6:7], v[10:11]
    s_waitcnt lgkmcnt(0)
    v_pk_add_f32 v[12:13], v[12:13], v[16:17]
    v_pk_add_f32 v[14:15], v[14:15], v[18:19]
    v_pk_add_f32 v[4:5], v[4:5], v[12:13]
    v_pk_add_f32 v[6:7], v[6:7], v[14:15]
    v_pk_fma_f32 v[100:101], v[96:97], v[24:25], v[100:101]
    v_pk_fma_f32 v[102:103], v[98:99], v[26:27], v[102:103]
    v_pk_fma_f32 v[4:5], v[4:5], v[20:21], v[100:101]
    v_pk_fma_f32 v[6:7], v[6:7], v[22:23], v[102:103]
    v_cvt_pk_bf16_f32 v4, 0, v4
    v_cvt_pk_bf16_f32 v5, 0, v5
    v_cvt_pk_bf16_f32 v6, 0, v6
    v_cvt_pk_bf16_f32 v7, 0, v7
    v_pk_mul_f32 v[12:13], v[4:5], v[4:5]
    v_pk_mul_f32 v[14:15], v[6:7], v[6:7]
    v_fma_f32 v12, v12, s75, v92
    v_fma_f32 v13, v13, s75, v92
    v_fma_f32 v14, v14, s75, v92
    v_fma_f32 v15, v15, s75, v92
    v_pk_mul_f32 v[12:13], v[12:13], v[4:5]
    v_pk_mul_f32 v[14:15], v[14:15], v[6:7]
    v_exp_f32 v12, v12
    v_exp_f32 v13, v13
    v_exp_f32 v14, v14
    v_exp_f32 v15, v15
    v_add_f32 v12, 1.0, v12
    v_add_f32 v13, 1.0, v13
    v_add_f32 v14, 1.0, v14
    v_add_f32 v15, 1.0, v15
    v_rcp_f32 v12, v12
    v_rcp_f32 v13, v13
    v_rcp_f32 v14, v14
    v_rcp_f32 v15, v15
    v_pk_mul_f32 v[12:13], v[12:13], v[4:5]
    v_pk_mul_f32 v[14:15], v[14:15], v[6:7]
    v_cvt_pk_bf16_f32 v12, 0, v12
    v_cvt_pk_bf16_f32 v13, 0, v13
    v_cvt_pk_bf16_f32 v14, 0, v14
    v_cvt_pk_bf16_f32 v15, 0, v15
    v_mul_f32_dpp v12, v4, v12 row_ror:8 row_mask:0xf bank_mask:0xf
    v_mul_f32_dpp v13, v5, v13 row_ror:8 row_mask:0xf bank_mask:0xf
    v_mul_f32_dpp v14, v6, v14 row_ror:8 row_mask:0xf bank_mask:0xf
    v_mul_f32_dpp v15, v7, v15 row_ror:8 row_mask:0xf bank_mask:0xf
    v_cvt_pk_bf16_f32 v8, v12, v13
    v_cvt_pk_bf16_f32 v9, v14, v15
    s_mov_b32 exec_lo, 0xff00ff
    s_mov_b32 exec_hi, 0xff00ff
    ds_write_b16 v88, v8
    ds_write_b16_d16_hi v88, v8 offset:64
    ds_write_b16 v88, v9 offset:128
    ds_write_b16_d16_hi v88, v9 offset:192
    s_mov_b32 exec_lo, 0xf000f
    s_mov_b32 exec_hi, 0xf000f
    ds_read_b128 v[72:75], v89
    s_mov_b32 exec_lo, 0xf000f0
    s_mov_b32 exec_hi, 0xf000f0
    ds_read_b128 v[76:79], v89
    s_mov_b32 exec_lo, 0xf000f00
    s_mov_b32 exec_hi, 0xf000f00
    ds_read_b128 v[80:83], v89
    s_mov_b32 exec_lo, 0xf000f000
    s_mov_b32 exec_hi, 0xf000f000
    ds_read_b128 v[84:87], v89
    s_mov_b64 exec, -1
    s_waitcnt lgkmcnt(3)
    v_mfma_f32_16x16x32_bf16 v[4:7], v[72:75], v[136:139], 0
    v_mfma_f32_16x16x32_bf16 v[8:11], v[72:75], v[152:155], 0
    s_waitcnt lgkmcnt(2)
    v_mfma_f32_16x16x32_bf16 v[4:7], v[76:79], v[140:143], v[4:7]
    v_mfma_f32_16x16x32_bf16 v[8:11], v[76:79], v[156:159], v[8:11]
    s_waitcnt lgkmcnt(1)
    v_mfma_f32_16x16x32_bf16 v[4:7], v[80:83], v[144:147], v[4:7]
    v_mfma_f32_16x16x32_bf16 v[8:11], v[80:83], v[160:163], v[8:11]
    s_waitcnt lgkmcnt(0)
    v_mfma_f32_16x16x32_bf16 v[4:7], v[84:87], v[148:151], v[4:7]
    v_mfma_f32_16x16x32_bf16 v[8:11], v[84:87], v[164:167], v[8:11]
    s_nop 6
    buffer_store_dwordx4 v[4:7], v90, s[40:43], s73 offen sc1
    buffer_store_dwordx4 v[8:11], v90, s[40:43], s73 offen offset:1024 sc1
    s_waitcnt vmcnt(0)
L_b7:
    s_barrier
L_fin:
L_end:
    s_endpgm
.section .rodata,"a"
.p2align 6
.amdhsa_kernel adaLN_cond__gqa_block_cached__geglu_ffn__decode_kernel
.amdhsa_next_free_vgpr 168
.amdhsa_next_free_sgpr 102
.amdhsa_accum_offset 168
.amdhsa_group_segment_fixed_size 0
.amdhsa_kernarg_size 112
.amdhsa_user_sgpr_count 2
.amdhsa_user_sgpr_kernarg_segment_ptr 1
.amdhsa_system_sgpr_workgroup_id_x 1
.amdhsa_float_denorm_mode_32 3
.end_amdhsa_kernel
```
